```python
import torch

def _softmax(x, axis=-1):
    return torch.softmax(x, dim=axis)
def _gelu(x):
    return torch.nn.functional.gelu(x, approximate="tanh")
def _silu(x):
    return torch.nn.functional.silu(x)
def _sigmoid(x):
    return torch.sigmoid(x)
def _layernorm(x, axis=-1, eps=1e-5):
    m = x.mean(dim=axis, keepdim=True)
    v = x.var(dim=axis, keepdim=True, unbiased=False)
    return (x - m) / torch.sqrt(v + eps)
def _scatter_add(tgt, idx, src, axis=0):
    return tgt.clone().index_add_(axis, idx, src)
def _segment_sum(src, seg, n):
    out = torch.zeros((n,) + src.shape[1:], dtype=src.dtype)
    return out.index_add_(0, seg, src)
def _pad(x, pw):
    flat = tuple(v for pair in reversed(pw) for v in pair)
    return torch.nn.functional.pad(x, flat)

kernel_name = 'sequential_preLN__spectral_fnet__moe_arch_mod__prompt'

def setup_inputs():

    _w = (lambda a: (lambda t: t.to(torch.bfloat16) if t.is_floating_point() else t)(torch.as_tensor(a)))
    def _A_setup():
        B, S, D = 1, 2048, 576
        ns = torch.arange(S)[:, None] * torch.arange(S)[None, :]
        nd = torch.arange(D)[:, None] * torch.arange(D)[None, :]
        Ws_re = torch.cos(-2.0 * torch.pi * ns / S).to(float)
        Ws_im = torch.sin(-2.0 * torch.pi * ns / S).to(float)
        Wd_re = torch.cos(-2.0 * torch.pi * nd / D).to(float)
        Wd_im = torch.sin(-2.0 * torch.pi * nd / D).to(float)
        return {
            "x": _w((lambda *s: torch.randn(*s, dtype=torch.bfloat16) * 0.05)(B, S, D)),
            "dft_seq_re": _w(Ws_re),
            "dft_seq_im": _w(Ws_im),
            "dft_hid_re": _w(Wd_re),
            "dft_hid_im": _w(Wd_im),
        }
    _A_in = _A_setup()

    def _B_setup():
        B, S, D, F, C = 1, 2048, 576, 4608, 1
        return {
            "x": _w((lambda *s: torch.randn(*s, dtype=torch.bfloat16) * 0.05)(B, S, D)),
            "w_r": _w((lambda *s: torch.randn(*s, dtype=torch.bfloat16) * 1.6)(D)),
            "w_gate": _w((lambda *s: torch.randn(*s, dtype=torch.bfloat16) * 0.4)(D, F)),
            "w_up": _w((lambda *s: torch.randn(*s, dtype=torch.bfloat16) * 0.4)(D, F)),
            "w_down": _w((lambda *s: torch.randn(*s, dtype=torch.bfloat16) * 0.4)(F, D)),
        }
    _B_in = _B_setup()

    return {
        "A_x": _A_in["x"],
        "A_dft_seq_re": _A_in["dft_seq_re"],
        "A_dft_seq_im": _A_in["dft_seq_im"],
        "A_dft_hid_re": _A_in["dft_hid_re"],
        "A_dft_hid_im": _A_in["dft_hid_im"],
        "B_x": _B_in["x"],
        "B_w_r": _B_in["w_r"],
        "B_w_gate": _B_in["w_gate"],
        "B_w_up": _B_in["w_up"],
        "B_w_down": _B_in["w_down"],
    }

def reference(A_x, A_dft_seq_re, A_dft_seq_im, A_dft_hid_re, A_dft_hid_im, B_x, B_w_r, B_w_gate, B_w_up, B_w_down):
    def _A_ref(x, dft_seq_re, dft_seq_im, dft_hid_re, dft_hid_im):
        a = torch.einsum("bsd,ed->bse", x, dft_hid_re)
        b = torch.einsum("bsd,ed->bse", x, dft_hid_im)
        y = torch.einsum("ts,bse->bte", dft_seq_re, a) - torch.einsum("ts,bse->bte", dft_seq_im, b)
        return y

    def _B_ref(x, w_r, w_gate, w_up, w_down):
        B, S, D = x.shape
        C = 1
        r = x @ w_r
        idx = torch.argsort(-r, axis=-1)[:, :C]
        idx_e = (lambda x, n, axis: torch.repeat_interleave(x, n, dim=axis))(idx.reshape(B, C, 1), D, axis=2)
        x_sel = (lambda x, i, axis: torch.take_along_dim(x, i, dim=axis))(x, idx_e, axis=1)
        g = _silu(x_sel @ w_gate)
        u = x_sel @ w_up
        y = (g * u) @ w_down
        r_sel = _sigmoid((lambda x, i, axis: torch.take_along_dim(x, i, dim=axis))(r, idx, axis=1))
        y = y * r_sel.reshape(B, C, 1)
        b_off = (torch.arange(B) * S).reshape(B, 1)
        flat_idx = (idx + b_off).reshape(B * C)
        zero = (x * 0.0).reshape(B * S, D)
        upd = _scatter_add(zero, flat_idx, y.reshape(B * C, D), axis=0)
        return x + upd.reshape(B, S, D)

    x = A_x
    h = x + _A_ref(_layernorm(x, axis=-1), A_dft_seq_re, A_dft_seq_im, A_dft_hid_re, A_dft_hid_im)
    h2 = h + _B_ref(_layernorm(h, axis=-1), B_w_r, B_w_gate, B_w_up, B_w_down)
    return h2
```

```asm
; @launch grid=(256,1,1) block=(512,1,1) lds=156288
.amdgcn_target "amdgcn-amd-amdhsa--gfx950"
.text
.globl sequential_preLN__spectral_fnet__moe_arch_mod__prompt_kernel
.p2align 8
.type sequential_preLN__spectral_fnet__moe_arch_mod__prompt_kernel,@function
sequential_preLN__spectral_fnet__moe_arch_mod__prompt_kernel:
    s_cmp_ge_u32 s2, 256
    s_cbranch_scc1 L_END
    s_load_dwordx8 s[4:11], s[0:1], 0
    s_load_dwordx2 s[12:13], s[0:1], 32
    s_load_dwordx2 s[14:15], s[0:1], 96
    s_load_dwordx8 s[64:71], s[0:1], 48
    s_load_dwordx4 s[72:75], s[0:1], 80
    v_lshrrev_b32 v1, 6, v0
    s_nop 0
    v_readfirstlane_b32 s40, v1
    s_cmp_ge_u32 s2, 64
    s_cbranch_scc1 L_PROD
L_HELP:
    s_cmp_ge_u32 s2, 16
    s_cbranch_scc1 L_HELP2
    v_lshlrev_b32 v13, 4, v0
    v_mov_b32 v28, -1
    v_mov_b32 v29, -1
    v_mov_b32 v30, -1
    v_mov_b32 v31, -1
    s_mul_i32 s54, s2, 24576
    s_add_u32 s54, s54, 2359296
    s_mov_b32 s62, 2701312
    s_mov_b32 s63, 0x00020000
    v_mov_b32 v6, 0
    v_mov_b32 v7, 1
    s_waitcnt lgkmcnt(0)
    s_mov_b32 s60, s14
    s_mov_b32 s61, s15
    buffer_store_dwordx4 v[28:31], v13, s[60:63], s54 offen sc1
    s_add_u32 s54, s54, 8192
    buffer_store_dwordx4 v[28:31], v13, s[60:63], s54 offen sc1
    s_add_u32 s54, s54, 8192
    buffer_store_dwordx4 v[28:31], v13, s[60:63], s54 offen sc1
    s_mov_b32 s76, s74
    s_mov_b32 s77, s75
    s_mov_b32 s78, 256
    s_mov_b32 s79, 0x00020000
    v_and_b32 v0, 63, v0
    s_and_b32 s41, s2, 7
    s_lshr_b32 s42, s2, 3
    s_waitcnt vmcnt(0)
    s_barrier
    s_cmp_lg_u32 s40, 7
    s_cbranch_scc1 L_HELP4
    s_mov_b64 exec, 1
    buffer_atomic_add v7, v6, s[76:79], 0 offen
    s_mov_b64 exec, -1
    s_branch L_HELP4
L_HELP2:
    v_and_b32 v0, 63, v0
    s_and_b32 s41, s2, 7
    s_lshr_b32 s42, s2, 3
    s_cmp_ge_u32 s40, 5
    s_cbranch_scc1 L_HELP3
    s_branch L_HELP4
L_HELP3:
    s_cmp_eq_u32 s40, 5
    s_cbranch_scc1 L_HELP5
    s_cmp_eq_u32 s40, 7
    s_cbranch_scc1 L_HELP4
    s_getpc_b64 s[76:77]
L_PC:
    s_sub_u32 s76, s76, L_PC-sequential_preLN__spectral_fnet__moe_arch_mod__prompt_kernel
    s_subb_u32 s77, s77, 0
    v_lshlrev_b32 v7, 7, v0
    v_cmp_gt_u32 vcc, CODE_END-sequential_preLN__spectral_fnet__moe_arch_mod__prompt_kernel, v7
    s_nop 1
    v_cndmask_b32 v8, 0, v7, vcc
    global_load_dword v20, v8, s[76:77]
    v_add_u32 v7, 8192, v7
    v_cmp_gt_u32 vcc, CODE_END-sequential_preLN__spectral_fnet__moe_arch_mod__prompt_kernel, v7
    s_nop 1
    v_cndmask_b32 v8, 0, v7, vcc
    global_load_dword v21, v8, s[76:77]
    v_add_u32 v7, 8192, v7
    v_cmp_gt_u32 vcc, CODE_END-sequential_preLN__spectral_fnet__moe_arch_mod__prompt_kernel, v7
    s_nop 1
    v_cndmask_b32 v8, 0, v7, vcc
    global_load_dword v22, v8, s[76:77]
    s_branch L_HELP4
L_HELP5:
L_HELP4:
    s_waitcnt lgkmcnt(0)
    s_waitcnt vmcnt(0)
    s_barrier
    s_cmp_ge_u32 s40, 2
    s_cbranch_scc1 L_FFN
    s_mov_b32 s16, s66
    s_mov_b32 s17, s67
    s_mov_b32 s18, 5308416
    s_mov_b32 s19, 0x00020000
    s_mov_b32 s20, s68
    s_mov_b32 s21, s69
    s_mov_b32 s22, 5308416
    s_mov_b32 s23, 0x00020000
    s_mov_b32 s24, s70
    s_mov_b32 s25, s71
    s_mov_b32 s26, 5308416
    s_mov_b32 s27, 0x00020000
    s_mul_i32 s43, s42, 72
    s_mul_i32 s44, s40, 36
    s_add_u32 s43, s43, s44
    s_mul_i32 s44, s41, 9
    s_add_u32 s44, s44, 8
    s_mul_i32 s45, s43, 9216
    s_lshl_b32 s46, s44, 7
    s_add_u32 s45, s45, s46
    s_mul_i32 s46, s44, 73728
    s_lshl_b32 s47, s43, 7
    s_add_u32 s46, s46, s47
    v_mul_u32_u24 v6, 9216, v0
    v_lshlrev_b32 v7, 7, v0
    s_mov_b32 exec_hi, 0xf
    buffer_load_dword v240, v6, s[16:19], s45 offen
    buffer_load_dword v241, v6, s[20:23], s45 offen
    buffer_load_dword v242, v7, s[24:27], s46 offen
    s_mov_b32 exec_hi, -1
    s_branch L_FFN
L_PROD:
    v_and_b32 v0, 63, v0
    s_and_b32 s41, s2, 31
    s_lshr_b32 s42, s2, 5
    s_sub_u32 s42, s42, 2
    v_lshrrev_b32 v3, 4, v0
    s_cmp_ge_u32 s42, 3
    s_cselect_b32 s43, 1, 0
    s_cmp_lt_u32 s40, 4
    s_cbranch_scc1 L_P1MM
    v_lshrrev_b32 v8, 3, v0
    v_and_b32 v9, 7, v0
    v_xor_b32 v9, v9, v3
    v_lshlrev_b32 v9, 4, v9
    s_sub_u32 s44, s40, 4
    s_lshr_b32 s45, s44, 1
    s_lshl_b32 s45, s45, 5
    s_and_b32 s51, s44, 1
    s_lshl_b32 s46, s51, 2
    s_add_u32 s45, s45, s46
    v_lshrrev_b32 v6, 2, v8
    v_lshlrev_b32 v6, 3, v6
    v_and_b32 v10, 3, v8
    v_add3_u32 v6, v6, v10, s45
    v_mul_u32_u24 v6, 36864, v6
    s_mul_i32 s47, s41, 1152
    v_xor_b32 v10, 64, v9
    v_add_u32 v7, s47, v6
    v_add_u32 v6, v7, v9
    v_add_u32 v7, v7, v10
    v_add_u32 v7, 589824, v7
    s_lshl_b32 s48, s44, 11
    s_waitcnt lgkmcnt(0)
    s_mov_b32 s16, s4
    s_mov_b32 s17, s5
    s_mov_b32 s18, 2359296
    s_mov_b32 s19, 0x00020000
    s_add_u32 m0, s48, 0
    s_nop 0
    buffer_load_dwordx4 v6, s[16:19], 0 offen offset:0 lds
    s_add_u32 m0, s48, 1024
    s_nop 0
    buffer_load_dwordx4 v7, s[16:19], 0 offen offset:0 lds
    s_add_u32 m0, s48, 8064
    s_nop 0
    buffer_load_dwordx4 v6, s[16:19], 0 offen offset:128 lds
    s_add_u32 m0, s48, 9088
    s_nop 0
    buffer_load_dwordx4 v7, s[16:19], 0 offen offset:128 lds
    s_add_u32 m0, s48, 16128
    s_nop 0
    buffer_load_dwordx4 v6, s[16:19], 0 offen offset:256 lds
    s_add_u32 m0, s48, 17152
    s_nop 0
    buffer_load_dwordx4 v7, s[16:19], 0 offen offset:256 lds
    s_add_u32 m0, s48, 24192
    s_nop 0
    buffer_load_dwordx4 v6, s[16:19], 0 offen offset:384 lds
    s_add_u32 m0, s48, 25216
    s_nop 0
    buffer_load_dwordx4 v7, s[16:19], 0 offen offset:384 lds
    s_add_u32 m0, s48, 32256
    s_nop 0
    buffer_load_dwordx4 v6, s[16:19], 0 offen offset:512 lds
    s_add_u32 m0, s48, 33280
    s_nop 0
    buffer_load_dwordx4 v7, s[16:19], 0 offen offset:512 lds
    s_add_u32 m0, s48, 40320
    s_nop 0
    buffer_load_dwordx4 v6, s[16:19], 0 offen offset:640 lds
    s_add_u32 m0, s48, 41344
    s_nop 0
    buffer_load_dwordx4 v7, s[16:19], 0 offen offset:640 lds
    s_add_u32 m0, s48, 48384
    s_nop 0
    buffer_load_dwordx4 v6, s[16:19], 0 offen offset:768 lds
    s_add_u32 m0, s48, 49408
    s_nop 0
    buffer_load_dwordx4 v7, s[16:19], 0 offen offset:768 lds
    s_add_u32 m0, s48, 56448
    s_nop 0
    buffer_load_dwordx4 v6, s[16:19], 0 offen offset:896 lds
    s_add_u32 m0, s48, 57472
    s_nop 0
    buffer_load_dwordx4 v7, s[16:19], 0 offen offset:896 lds
    s_add_u32 m0, s48, 64512
    s_nop 0
    buffer_load_dwordx4 v6, s[16:19], 0 offen offset:1024 lds
    s_add_u32 m0, s48, 65536
    s_nop 0
    buffer_load_dwordx4 v7, s[16:19], 0 offen offset:1024 lds
    v_and_b32 v14, 7, v0
    s_lshl_b32 s46, s44, 3
    v_add_u32 v14, s46, v14
    v_sub_u32 v15, 64, v14
    v_cmp_eq_u32 vcc, 64, v15
    s_nop 1
    v_cndmask_b32 v15, v15, 32, vcc
    v_and_b32 v16, 8, v0
    v_cmp_eq_u32 vcc, 0, v16
    s_nop 1
    v_cndmask_b32 v14, v15, v14, vcc
    v_cvt_f32_u32 v14, v14
    v_mul_f32 v14, 0xbc800000, v14
    v_lshlrev_b32 v15, 3, v3
    v_cvt_f32_u32 v15, v15
    v_mul_f32 v15, v15, v14
    s_lshl_b32 s49, s44, 12
    s_add_u32 s49, s49, 135168
    v_lshl_add_u32 v16, v0, 4, s49
    s_waitcnt vmcnt(14)
    s_barrier
    v_mul_f32 v56, 0x00000000, v14
    v_mul_f32 v57, 0x3f800000, v14
    v_mul_f32 v58, 0x40000000, v14
    v_mul_f32 v59, 0x40400000, v14
    v_mul_f32 v60, 0x40800000, v14
    v_mul_f32 v61, 0x40a00000, v14
    v_mul_f32 v62, 0x40c00000, v14
    v_mul_f32 v63, 0x40e00000, v14
    v_cos_f32 v48, v56
    v_sin_f32 v56, v56
    v_cos_f32 v49, v57
    v_sin_f32 v57, v57
    v_cos_f32 v50, v58
    v_sin_f32 v58, v58
    v_cos_f32 v51, v59
    v_sin_f32 v59, v59
    v_cos_f32 v52, v60
    v_sin_f32 v60, v60
    v_cos_f32 v53, v61
    v_sin_f32 v61, v61
    v_cos_f32 v54, v62
    v_sin_f32 v62, v62
    v_cos_f32 v55, v63
    v_sin_f32 v63, v63
    v_mul_f32 v14, 0x42000000, v14
    s_mov_b32 s53, 2
L_GF:
    v_cos_f32 v80, v15
    v_sin_f32 v82, v15
    v_add_f32 v15, v15, v14
    s_sub_u32 s53, s53, 1
    v_pk_mul_f32 v[64:65], v[48:49], v[80:81] op_sel_hi:[1,0]
    v_pk_mul_f32 v[72:73], v[56:57], v[80:81] op_sel_hi:[1,0]
    v_pk_mul_f32 v[66:67], v[50:51], v[80:81] op_sel_hi:[1,0]
    v_pk_mul_f32 v[74:75], v[58:59], v[80:81] op_sel_hi:[1,0]
    v_pk_mul_f32 v[68:69], v[52:53], v[80:81] op_sel_hi:[1,0]
    v_pk_mul_f32 v[76:77], v[60:61], v[80:81] op_sel_hi:[1,0]
    v_pk_mul_f32 v[70:71], v[54:55], v[80:81] op_sel_hi:[1,0]
    v_pk_mul_f32 v[78:79], v[62:63], v[80:81] op_sel_hi:[1,0]
    v_pk_fma_f32 v[64:65], v[56:57], v[82:83], v[64:65] op_sel_hi:[1,0,1] neg_lo:[0,1,0] neg_hi:[0,1,0]
    v_pk_fma_f32 v[72:73], v[48:49], v[82:83], v[72:73] op_sel_hi:[1,0,1]
    v_pk_fma_f32 v[66:67], v[58:59], v[82:83], v[66:67] op_sel_hi:[1,0,1] neg_lo:[0,1,0] neg_hi:[0,1,0]
    v_pk_fma_f32 v[74:75], v[50:51], v[82:83], v[74:75] op_sel_hi:[1,0,1]
    v_pk_fma_f32 v[68:69], v[60:61], v[82:83], v[68:69] op_sel_hi:[1,0,1] neg_lo:[0,1,0] neg_hi:[0,1,0]
    v_pk_fma_f32 v[76:77], v[52:53], v[82:83], v[76:77] op_sel_hi:[1,0,1]
    v_pk_fma_f32 v[70:71], v[62:63], v[82:83], v[70:71] op_sel_hi:[1,0,1] neg_lo:[0,1,0] neg_hi:[0,1,0]
    v_pk_fma_f32 v[78:79], v[54:55], v[82:83], v[78:79] op_sel_hi:[1,0,1]
    s_waitcnt lgkmcnt(0)
    v_cvt_pk_bf16_f32 v84, v64, v65
    v_cvt_pk_bf16_f32 v88, v72, v73
    v_cvt_pk_bf16_f32 v85, v66, v67
    v_cvt_pk_bf16_f32 v89, v74, v75
    v_cvt_pk_bf16_f32 v86, v68, v69
    v_cvt_pk_bf16_f32 v90, v76, v77
    v_cvt_pk_bf16_f32 v87, v70, v71
    v_cvt_pk_bf16_f32 v91, v78, v79
    ds_write_b128 v16, v[84:87]
    ds_write_b128 v16, v[88:91] offset:1024
    v_add_u32 v16, 2048, v16
    s_cmp_lg_u32 s53, 0
    s_cbranch_scc1 L_GF
    s_waitcnt lgkmcnt(0)
    s_mov_b32 s32, s66
    s_mov_b32 s33, s67
    s_mov_b32 s34, 5308416
    s_mov_b32 s35, 0x00020000
    s_mov_b32 s36, s68
    s_mov_b32 s37, s69
    s_mov_b32 s38, 5308416
    s_mov_b32 s39, 0x00020000
    s_mov_b32 s60, s70
    s_mov_b32 s61, s71
    s_mov_b32 s62, 5308416
    s_mov_b32 s63, 0x00020000
    s_sub_u32 s54, s2, 64
    s_lshr_b32 s54, s54, 3
    s_lshl_b32 s54, s54, 2
    s_add_u32 s54, s54, s44
    s_and_b32 s55, s2, 7
    s_mul_i32 s56, s54, 55296
    s_mul_i32 s57, s55, 1152
    s_add_u32 s56, s56, s57
    s_mul_i32 s57, s55, 663552
    s_mul_i32 s58, s54, 6912
    s_add_u32 s57, s57, s58
    s_mov_b32 s58, 0x1c72
    v_mul_u32_u24 v44, s58, v0
    v_lshrrev_b32 v44, 16, v44
    v_mul_u32_u24 v45, 9, v44
    v_sub_u32 v45, v0, v45
    v_mul_u32_u24 v44, 9216, v44
    v_lshl_add_u32 v44, v45, 7, v44
    v_lshlrev_b32 v45, 7, v0
    s_mov_b32 exec_hi, 0x3fffff
    buffer_load_dword v240, v44, s[32:35], s56 offen
    buffer_load_dword v241, v44, s[36:39], s56 offen
    buffer_load_dword v242, v45, s[60:63], s57 offen
    s_mov_b32 exec_hi, -1
    s_waitcnt vmcnt(11)
    s_barrier
    s_waitcnt vmcnt(3)
    s_barrier
    s_barrier
    s_cmp_lt_u32 s2, 128
    s_cbranch_scc1 L_P2
    s_barrier
    s_branch L_ROWP
L_P1MM:
    s_setprio 2
    v_and_b32 v2, 15, v0
    v_lshrrev_b32 v4, 1, v2
    v_xor_b32 v4, v4, v3
    v_lshlrev_b32 v4, 4, v4
    v_lshl_add_u32 v4, v2, 7, v4
    v_xor_b32 v5, 64, v4
    v_mov_b32 v12, 0x3f803f80
    v_mov_b32 v13, 0x3f803f80
    v_mov_b32 v14, 0x3f803f80
    v_mov_b32 v15, 0x3f803f80
    v_add_u32 v242, 0x10000, v4
    v_add_u32 v243, 0x10000, v5
    s_waitcnt lgkmcnt(0)
    s_cmp_eq_u32 s40, 3
    s_cbranch_scc1 L_STATS
    s_mul_i32 s44, s42, 3
    s_add_u32 s44, s44, s40
    s_mul_i32 s48, s40, 20480
    s_add_u32 s48, s48, 73728
    s_mov_b32 s36, s14
    s_mov_b32 s37, s15
    s_mov_b32 s38, 9437184
    s_mov_b32 s39, 0x00020000
    v_add_u32 v244, s48, v4
    v_add_u32 v246, 135168, v4
    v_add_u32 v245, s48, v5
    v_add_u32 v247, 135168, v5
    s_lshr_b32 s46, s41, 1
    s_and_b32 s46, s46, 1
    s_xor_b32 s46, s46, s44
    s_lshl_b32 s46, s46, 7
    s_mul_i32 s47, s41, 2304
    s_add_u32 s46, s46, s47
    s_and_b32 s47, s41, 1
    s_lshl_b32 s47, s47, 2
    v_lshrrev_b32 v7, 3, v0
    v_and_b32 v9, 7, v0
    v_xor_b32 v9, v9, v7
    v_xor_b32 v9, s47, v9
    v_mul_u32_u24 v7, 73728, v7
    v_lshl_add_u32 v7, v9, 4, v7
    v_add_u32 v7, s46, v7
    v_and_b32 v9, 7, v2
    v_lshrrev_b32 v240, 3, v2
    v_lshl_add_u32 v240, v240, 2, v3
    v_xor_b32 v240, v240, v9
    v_lshlrev_b32 v240, 4, v240
    v_lshl_add_u32 v240, v9, 7, v240
    s_lshl_b32 s47, s40, 12
    v_add_u32 v240, s47, v240
    v_lshl_add_u32 v241, v0, 4, s47
    v_lshlrev_b32 v8, 4, v3
    v_add_u32 v8, 151552, v8
    s_cmp_eq_u32 s43, 0
    s_cselect_b32 s47, 1.0, -1.0
    v_mov_b32 v10, s47
    v_mov_b32 v11, s47
    s_mov_b32 s60, 589824
    s_mov_b32 s61, 1179648
    s_mov_b32 s62, 1769472
    v_lshlrev_b32 v246, 4, v0
    v_add_u32 v246, 135168, v246
    s_mul_i32 s50, s42, 96
    s_mul_i32 s51, s43, 287
    s_sub_u32 s50, s50, s51
    s_lshl_b32 s51, s40, 5
    s_add_u32 s50, s50, s51
    v_lshl_add_u32 v244, v2, 1, s50
    v_cmp_eq_u32 vcc, 0, v244
    v_mov_b32 v245, 288
    s_nop 0
    v_cndmask_b32 v244, v244, v245, vcc
    v_cvt_f32_u32 v244, v244
    v_mul_f32 v244, 0xbae38e39, v244
    v_lshlrev_b32 v245, 3, v3
    v_cvt_f32_u32 v245, v245
    v_mul_f32 v245, v245, v244
    v_mul_f32 v216, 0x00000000, v244
    v_mul_f32 v217, 0x3f800000, v244
    v_mul_f32 v218, 0x40000000, v244
    v_mul_f32 v219, 0x40400000, v244
    v_mul_f32 v220, 0x40800000, v244
    v_mul_f32 v221, 0x40a00000, v244
    v_mul_f32 v222, 0x40c00000, v244
    v_mul_f32 v223, 0x40e00000, v244
    v_lshl_add_u32 v247, v0, 4, s48
    v_fmamk_f32 v162, v244, 0x00000000, v245
    v_fmamk_f32 v166, v244, 0x42000000, v245
    v_fmamk_f32 v170, v244, 0x42800000, v245
    v_fmamk_f32 v174, v244, 0x42c00000, v245
    v_fmamk_f32 v178, v244, 0x43000000, v245
    v_fmamk_f32 v182, v244, 0x43200000, v245
    v_fmamk_f32 v186, v244, 0x43400000, v245
    v_fmamk_f32 v190, v244, 0x43600000, v245
    v_fmamk_f32 v194, v244, 0x43800000, v245
    v_cos_f32 v208, v216
    v_sin_f32 v216, v216
    v_cos_f32 v209, v217
    v_sin_f32 v217, v217
    v_cos_f32 v210, v218
    v_sin_f32 v218, v218
    v_cos_f32 v211, v219
    v_sin_f32 v219, v219
    v_cos_f32 v212, v220
    v_sin_f32 v220, v220
    v_cos_f32 v213, v221
    v_sin_f32 v221, v221
    v_cos_f32 v214, v222
    v_sin_f32 v222, v222
    v_cos_f32 v215, v223
    v_sin_f32 v223, v223
    v_cos_f32 v160, v162
    v_sin_f32 v162, v162
    v_cos_f32 v164, v166
    v_sin_f32 v166, v166
    v_cos_f32 v168, v170
    v_sin_f32 v170, v170
    v_cos_f32 v172, v174
    v_sin_f32 v174, v174
    v_cos_f32 v176, v178
    v_sin_f32 v178, v178
    v_cos_f32 v180, v182
    v_sin_f32 v182, v182
    v_cos_f32 v184, v186
    v_sin_f32 v186, v186
    v_cos_f32 v188, v190
    v_sin_f32 v190, v190
    v_cos_f32 v192, v194
    v_sin_f32 v194, v194
    v_pk_mul_f32 v[224:225], v[208:209], v[160:161] op_sel_hi:[1,0]
    v_pk_mul_f32 v[232:233], v[216:217], v[160:161] op_sel_hi:[1,0]
    v_pk_mul_f32 v[226:227], v[210:211], v[160:161] op_sel_hi:[1,0]
    v_pk_mul_f32 v[234:235], v[218:219], v[160:161] op_sel_hi:[1,0]
    v_pk_mul_f32 v[228:229], v[212:213], v[160:161] op_sel_hi:[1,0]
    v_pk_mul_f32 v[236:237], v[220:221], v[160:161] op_sel_hi:[1,0]
    v_pk_mul_f32 v[230:231], v[214:215], v[160:161] op_sel_hi:[1,0]
    v_pk_mul_f32 v[238:239], v[222:223], v[160:161] op_sel_hi:[1,0]
    v_pk_fma_f32 v[224:225], v[216:217], v[162:163], v[224:225] op_sel_hi:[1,0,1] neg_lo:[0,1,0] neg_hi:[0,1,0]
    v_pk_fma_f32 v[232:233], v[208:209], v[162:163], v[232:233] op_sel_hi:[1,0,1]
    v_pk_fma_f32 v[226:227], v[218:219], v[162:163], v[226:227] op_sel_hi:[1,0,1] neg_lo:[0,1,0] neg_hi:[0,1,0]
    v_pk_fma_f32 v[234:235], v[210:211], v[162:163], v[234:235] op_sel_hi:[1,0,1]
    v_pk_fma_f32 v[228:229], v[220:221], v[162:163], v[228:229] op_sel_hi:[1,0,1] neg_lo:[0,1,0] neg_hi:[0,1,0]
    v_pk_fma_f32 v[236:237], v[212:213], v[162:163], v[236:237] op_sel_hi:[1,0,1]
    v_pk_fma_f32 v[230:231], v[222:223], v[162:163], v[230:231] op_sel_hi:[1,0,1] neg_lo:[0,1,0] neg_hi:[0,1,0]
    v_pk_fma_f32 v[238:239], v[214:215], v[162:163], v[238:239] op_sel_hi:[1,0,1]
    v_cvt_pk_bf16_f32 v16, v224, v225
    v_cvt_pk_bf16_f32 v20, v232, v233
    v_cvt_pk_bf16_f32 v17, v226, v227
    v_cvt_pk_bf16_f32 v21, v234, v235
    v_cvt_pk_bf16_f32 v18, v228, v229
    v_cvt_pk_bf16_f32 v22, v236, v237
    v_cvt_pk_bf16_f32 v19, v230, v231
    v_cvt_pk_bf16_f32 v23, v238, v239
    v_pk_mul_f32 v[224:225], v[208:209], v[164:165] op_sel_hi:[1,0]
    v_pk_mul_f32 v[232:233], v[216:217], v[164:165] op_sel_hi:[1,0]
    v_pk_mul_f32 v[226:227], v[210:211], v[164:165] op_sel_hi:[1,0]
    v_pk_mul_f32 v[234:235], v[218:219], v[164:165] op_sel_hi:[1,0]
    v_pk_mul_f32 v[228:229], v[212:213], v[164:165] op_sel_hi:[1,0]
    v_pk_mul_f32 v[236:237], v[220:221], v[164:165] op_sel_hi:[1,0]
    v_pk_mul_f32 v[230:231], v[214:215], v[164:165] op_sel_hi:[1,0]
    v_pk_mul_f32 v[238:239], v[222:223], v[164:165] op_sel_hi:[1,0]
    v_pk_fma_f32 v[224:225], v[216:217], v[166:167], v[224:225] op_sel_hi:[1,0,1] neg_lo:[0,1,0] neg_hi:[0,1,0]
    v_pk_fma_f32 v[232:233], v[208:209], v[166:167], v[232:233] op_sel_hi:[1,0,1]
    v_pk_fma_f32 v[226:227], v[218:219], v[166:167], v[226:227] op_sel_hi:[1,0,1] neg_lo:[0,1,0] neg_hi:[0,1,0]
    v_pk_fma_f32 v[234:235], v[210:211], v[166:167], v[234:235] op_sel_hi:[1,0,1]
    v_pk_fma_f32 v[228:229], v[220:221], v[166:167], v[228:229] op_sel_hi:[1,0,1] neg_lo:[0,1,0] neg_hi:[0,1,0]
    v_pk_fma_f32 v[236:237], v[212:213], v[166:167], v[236:237] op_sel_hi:[1,0,1]
    v_pk_fma_f32 v[230:231], v[222:223], v[166:167], v[230:231] op_sel_hi:[1,0,1] neg_lo:[0,1,0] neg_hi:[0,1,0]
    v_pk_fma_f32 v[238:239], v[214:215], v[166:167], v[238:239] op_sel_hi:[1,0,1]
    v_cvt_pk_bf16_f32 v24, v224, v225
    v_cvt_pk_bf16_f32 v28, v232, v233
    v_cvt_pk_bf16_f32 v25, v226, v227
    v_cvt_pk_bf16_f32 v29, v234, v235
    v_cvt_pk_bf16_f32 v26, v228, v229
    v_cvt_pk_bf16_f32 v30, v236, v237
    v_cvt_pk_bf16_f32 v27, v230, v231
    v_cvt_pk_bf16_f32 v31, v238, v239
    v_pk_mul_f32 v[224:225], v[208:209], v[168:169] op_sel_hi:[1,0]
    v_pk_mul_f32 v[232:233], v[216:217], v[168:169] op_sel_hi:[1,0]
    v_pk_mul_f32 v[226:227], v[210:211], v[168:169] op_sel_hi:[1,0]
    v_pk_mul_f32 v[234:235], v[218:219], v[168:169] op_sel_hi:[1,0]
    v_pk_mul_f32 v[228:229], v[212:213], v[168:169] op_sel_hi:[1,0]
    v_pk_mul_f32 v[236:237], v[220:221], v[168:169] op_sel_hi:[1,0]
    v_pk_mul_f32 v[230:231], v[214:215], v[168:169] op_sel_hi:[1,0]
    v_pk_mul_f32 v[238:239], v[222:223], v[168:169] op_sel_hi:[1,0]
    v_pk_fma_f32 v[224:225], v[216:217], v[170:171], v[224:225] op_sel_hi:[1,0,1] neg_lo:[0,1,0] neg_hi:[0,1,0]
    v_pk_fma_f32 v[232:233], v[208:209], v[170:171], v[232:233] op_sel_hi:[1,0,1]
    v_pk_fma_f32 v[226:227], v[218:219], v[170:171], v[226:227] op_sel_hi:[1,0,1] neg_lo:[0,1,0] neg_hi:[0,1,0]
    v_pk_fma_f32 v[234:235], v[210:211], v[170:171], v[234:235] op_sel_hi:[1,0,1]
    v_pk_fma_f32 v[228:229], v[220:221], v[170:171], v[228:229] op_sel_hi:[1,0,1] neg_lo:[0,1,0] neg_hi:[0,1,0]
    v_pk_fma_f32 v[236:237], v[212:213], v[170:171], v[236:237] op_sel_hi:[1,0,1]
    v_pk_fma_f32 v[230:231], v[222:223], v[170:171], v[230:231] op_sel_hi:[1,0,1] neg_lo:[0,1,0] neg_hi:[0,1,0]
    v_pk_fma_f32 v[238:239], v[214:215], v[170:171], v[238:239] op_sel_hi:[1,0,1]
    v_cvt_pk_bf16_f32 v32, v224, v225
    v_cvt_pk_bf16_f32 v36, v232, v233
    v_cvt_pk_bf16_f32 v33, v226, v227
    v_cvt_pk_bf16_f32 v37, v234, v235
    v_cvt_pk_bf16_f32 v34, v228, v229
    v_cvt_pk_bf16_f32 v38, v236, v237
    v_cvt_pk_bf16_f32 v35, v230, v231
    v_cvt_pk_bf16_f32 v39, v238, v239
    v_pk_mul_f32 v[224:225], v[208:209], v[172:173] op_sel_hi:[1,0]
    v_pk_mul_f32 v[232:233], v[216:217], v[172:173] op_sel_hi:[1,0]
    v_pk_mul_f32 v[226:227], v[210:211], v[172:173] op_sel_hi:[1,0]
    v_pk_mul_f32 v[234:235], v[218:219], v[172:173] op_sel_hi:[1,0]
    v_pk_mul_f32 v[228:229], v[212:213], v[172:173] op_sel_hi:[1,0]
    v_pk_mul_f32 v[236:237], v[220:221], v[172:173] op_sel_hi:[1,0]
    v_pk_mul_f32 v[230:231], v[214:215], v[172:173] op_sel_hi:[1,0]
    v_pk_mul_f32 v[238:239], v[222:223], v[172:173] op_sel_hi:[1,0]
    v_pk_fma_f32 v[224:225], v[216:217], v[174:175], v[224:225] op_sel_hi:[1,0,1] neg_lo:[0,1,0] neg_hi:[0,1,0]
    v_pk_fma_f32 v[232:233], v[208:209], v[174:175], v[232:233] op_sel_hi:[1,0,1]
    v_pk_fma_f32 v[226:227], v[218:219], v[174:175], v[226:227] op_sel_hi:[1,0,1] neg_lo:[0,1,0] neg_hi:[0,1,0]
    v_pk_fma_f32 v[234:235], v[210:211], v[174:175], v[234:235] op_sel_hi:[1,0,1]
    v_pk_fma_f32 v[228:229], v[220:221], v[174:175], v[228:229] op_sel_hi:[1,0,1] neg_lo:[0,1,0] neg_hi:[0,1,0]
    v_pk_fma_f32 v[236:237], v[212:213], v[174:175], v[236:237] op_sel_hi:[1,0,1]
    v_pk_fma_f32 v[230:231], v[222:223], v[174:175], v[230:231] op_sel_hi:[1,0,1] neg_lo:[0,1,0] neg_hi:[0,1,0]
    v_pk_fma_f32 v[238:239], v[214:215], v[174:175], v[238:239] op_sel_hi:[1,0,1]
    v_cvt_pk_bf16_f32 v40, v224, v225
    v_cvt_pk_bf16_f32 v44, v232, v233
    v_cvt_pk_bf16_f32 v41, v226, v227
    v_cvt_pk_bf16_f32 v45, v234, v235
    v_cvt_pk_bf16_f32 v42, v228, v229
    v_cvt_pk_bf16_f32 v46, v236, v237
    v_cvt_pk_bf16_f32 v43, v230, v231
    v_cvt_pk_bf16_f32 v47, v238, v239
    v_pk_mul_f32 v[224:225], v[208:209], v[176:177] op_sel_hi:[1,0]
    v_pk_mul_f32 v[232:233], v[216:217], v[176:177] op_sel_hi:[1,0]
    v_pk_mul_f32 v[226:227], v[210:211], v[176:177] op_sel_hi:[1,0]
    v_pk_mul_f32 v[234:235], v[218:219], v[176:177] op_sel_hi:[1,0]
    v_pk_mul_f32 v[228:229], v[212:213], v[176:177] op_sel_hi:[1,0]
    v_pk_mul_f32 v[236:237], v[220:221], v[176:177] op_sel_hi:[1,0]
    v_pk_mul_f32 v[230:231], v[214:215], v[176:177] op_sel_hi:[1,0]
    v_pk_mul_f32 v[238:239], v[222:223], v[176:177] op_sel_hi:[1,0]
    v_pk_fma_f32 v[224:225], v[216:217], v[178:179], v[224:225] op_sel_hi:[1,0,1] neg_lo:[0,1,0] neg_hi:[0,1,0]
    v_pk_fma_f32 v[232:233], v[208:209], v[178:179], v[232:233] op_sel_hi:[1,0,1]
    v_pk_fma_f32 v[226:227], v[218:219], v[178:179], v[226:227] op_sel_hi:[1,0,1] neg_lo:[0,1,0] neg_hi:[0,1,0]
    v_pk_fma_f32 v[234:235], v[210:211], v[178:179], v[234:235] op_sel_hi:[1,0,1]
    v_pk_fma_f32 v[228:229], v[220:221], v[178:179], v[228:229] op_sel_hi:[1,0,1] neg_lo:[0,1,0] neg_hi:[0,1,0]
    v_pk_fma_f32 v[236:237], v[212:213], v[178:179], v[236:237] op_sel_hi:[1,0,1]
    v_pk_fma_f32 v[230:231], v[222:223], v[178:179], v[230:231] op_sel_hi:[1,0,1] neg_lo:[0,1,0] neg_hi:[0,1,0]
    v_pk_fma_f32 v[238:239], v[214:215], v[178:179], v[238:239] op_sel_hi:[1,0,1]
    v_cvt_pk_bf16_f32 v48, v224, v225
    v_cvt_pk_bf16_f32 v52, v232, v233
    v_cvt_pk_bf16_f32 v49, v226, v227
    v_cvt_pk_bf16_f32 v53, v234, v235
    v_cvt_pk_bf16_f32 v50, v228, v229
    v_cvt_pk_bf16_f32 v54, v236, v237
    v_cvt_pk_bf16_f32 v51, v230, v231
    v_cvt_pk_bf16_f32 v55, v238, v239
    v_pk_mul_f32 v[224:225], v[208:209], v[180:181] op_sel_hi:[1,0]
    v_pk_mul_f32 v[232:233], v[216:217], v[180:181] op_sel_hi:[1,0]
    v_pk_mul_f32 v[226:227], v[210:211], v[180:181] op_sel_hi:[1,0]
    v_pk_mul_f32 v[234:235], v[218:219], v[180:181] op_sel_hi:[1,0]
    v_pk_mul_f32 v[228:229], v[212:213], v[180:181] op_sel_hi:[1,0]
    v_pk_mul_f32 v[236:237], v[220:221], v[180:181] op_sel_hi:[1,0]
    v_pk_mul_f32 v[230:231], v[214:215], v[180:181] op_sel_hi:[1,0]
    v_pk_mul_f32 v[238:239], v[222:223], v[180:181] op_sel_hi:[1,0]
    v_pk_fma_f32 v[224:225], v[216:217], v[182:183], v[224:225] op_sel_hi:[1,0,1] neg_lo:[0,1,0] neg_hi:[0,1,0]
    v_pk_fma_f32 v[232:233], v[208:209], v[182:183], v[232:233] op_sel_hi:[1,0,1]
    v_pk_fma_f32 v[226:227], v[218:219], v[182:183], v[226:227] op_sel_hi:[1,0,1] neg_lo:[0,1,0] neg_hi:[0,1,0]
    v_pk_fma_f32 v[234:235], v[210:211], v[182:183], v[234:235] op_sel_hi:[1,0,1]
    v_pk_fma_f32 v[228:229], v[220:221], v[182:183], v[228:229] op_sel_hi:[1,0,1] neg_lo:[0,1,0] neg_hi:[0,1,0]
    v_pk_fma_f32 v[236:237], v[212:213], v[182:183], v[236:237] op_sel_hi:[1,0,1]
    v_pk_fma_f32 v[230:231], v[222:223], v[182:183], v[230:231] op_sel_hi:[1,0,1] neg_lo:[0,1,0] neg_hi:[0,1,0]
    v_pk_fma_f32 v[238:239], v[214:215], v[182:183], v[238:239] op_sel_hi:[1,0,1]
    v_cvt_pk_bf16_f32 v56, v224, v225
    v_cvt_pk_bf16_f32 v60, v232, v233
    v_cvt_pk_bf16_f32 v57, v226, v227
    v_cvt_pk_bf16_f32 v61, v234, v235
    v_cvt_pk_bf16_f32 v58, v228, v229
    v_cvt_pk_bf16_f32 v62, v236, v237
    v_cvt_pk_bf16_f32 v59, v230, v231
    v_cvt_pk_bf16_f32 v63, v238, v239
    v_pk_mul_f32 v[224:225], v[208:209], v[184:185] op_sel_hi:[1,0]
    v_pk_mul_f32 v[232:233], v[216:217], v[184:185] op_sel_hi:[1,0]
    v_pk_mul_f32 v[226:227], v[210:211], v[184:185] op_sel_hi:[1,0]
    v_pk_mul_f32 v[234:235], v[218:219], v[184:185] op_sel_hi:[1,0]
    v_pk_mul_f32 v[228:229], v[212:213], v[184:185] op_sel_hi:[1,0]
    v_pk_mul_f32 v[236:237], v[220:221], v[184:185] op_sel_hi:[1,0]
    v_pk_mul_f32 v[230:231], v[214:215], v[184:185] op_sel_hi:[1,0]
    v_pk_mul_f32 v[238:239], v[222:223], v[184:185] op_sel_hi:[1,0]
    v_pk_fma_f32 v[224:225], v[216:217], v[186:187], v[224:225] op_sel_hi:[1,0,1] neg_lo:[0,1,0] neg_hi:[0,1,0]
    v_pk_fma_f32 v[232:233], v[208:209], v[186:187], v[232:233] op_sel_hi:[1,0,1]
    v_pk_fma_f32 v[226:227], v[218:219], v[186:187], v[226:227] op_sel_hi:[1,0,1] neg_lo:[0,1,0] neg_hi:[0,1,0]
    v_pk_fma_f32 v[234:235], v[210:211], v[186:187], v[234:235] op_sel_hi:[1,0,1]
    v_pk_fma_f32 v[228:229], v[220:221], v[186:187], v[228:229] op_sel_hi:[1,0,1] neg_lo:[0,1,0] neg_hi:[0,1,0]
    v_pk_fma_f32 v[236:237], v[212:213], v[186:187], v[236:237] op_sel_hi:[1,0,1]
    v_pk_fma_f32 v[230:231], v[222:223], v[186:187], v[230:231] op_sel_hi:[1,0,1] neg_lo:[0,1,0] neg_hi:[0,1,0]
    v_pk_fma_f32 v[238:239], v[214:215], v[186:187], v[238:239] op_sel_hi:[1,0,1]
    v_cvt_pk_bf16_f32 v64, v224, v225
    v_cvt_pk_bf16_f32 v68, v232, v233
    v_cvt_pk_bf16_f32 v65, v226, v227
    v_cvt_pk_bf16_f32 v69, v234, v235
    v_cvt_pk_bf16_f32 v66, v228, v229
    v_cvt_pk_bf16_f32 v70, v236, v237
    v_cvt_pk_bf16_f32 v67, v230, v231
    v_cvt_pk_bf16_f32 v71, v238, v239
    v_pk_mul_f32 v[224:225], v[208:209], v[188:189] op_sel_hi:[1,0]
    v_pk_mul_f32 v[232:233], v[216:217], v[188:189] op_sel_hi:[1,0]
    v_pk_mul_f32 v[226:227], v[210:211], v[188:189] op_sel_hi:[1,0]
    v_pk_mul_f32 v[234:235], v[218:219], v[188:189] op_sel_hi:[1,0]
    v_pk_mul_f32 v[228:229], v[212:213], v[188:189] op_sel_hi:[1,0]
    v_pk_mul_f32 v[236:237], v[220:221], v[188:189] op_sel_hi:[1,0]
    v_pk_mul_f32 v[230:231], v[214:215], v[188:189] op_sel_hi:[1,0]
    v_pk_mul_f32 v[238:239], v[222:223], v[188:189] op_sel_hi:[1,0]
    v_pk_fma_f32 v[224:225], v[216:217], v[190:191], v[224:225] op_sel_hi:[1,0,1] neg_lo:[0,1,0] neg_hi:[0,1,0]
    v_pk_fma_f32 v[232:233], v[208:209], v[190:191], v[232:233] op_sel_hi:[1,0,1]
    v_pk_fma_f32 v[226:227], v[218:219], v[190:191], v[226:227] op_sel_hi:[1,0,1] neg_lo:[0,1,0] neg_hi:[0,1,0]
    v_pk_fma_f32 v[234:235], v[210:211], v[190:191], v[234:235] op_sel_hi:[1,0,1]
    v_pk_fma_f32 v[228:229], v[220:221], v[190:191], v[228:229] op_sel_hi:[1,0,1] neg_lo:[0,1,0] neg_hi:[0,1,0]
    v_pk_fma_f32 v[236:237], v[212:213], v[190:191], v[236:237] op_sel_hi:[1,0,1]
    v_pk_fma_f32 v[230:231], v[222:223], v[190:191], v[230:231] op_sel_hi:[1,0,1] neg_lo:[0,1,0] neg_hi:[0,1,0]
    v_pk_fma_f32 v[238:239], v[214:215], v[190:191], v[238:239] op_sel_hi:[1,0,1]
    v_cvt_pk_bf16_f32 v72, v224, v225
    v_cvt_pk_bf16_f32 v76, v232, v233
    v_cvt_pk_bf16_f32 v73, v226, v227
    v_cvt_pk_bf16_f32 v77, v234, v235
    v_cvt_pk_bf16_f32 v74, v228, v229
    v_cvt_pk_bf16_f32 v78, v236, v237
    v_cvt_pk_bf16_f32 v75, v230, v231
    v_cvt_pk_bf16_f32 v79, v238, v239
    v_pk_mul_f32 v[224:225], v[208:209], v[192:193] op_sel_hi:[1,0]
    v_pk_mul_f32 v[232:233], v[216:217], v[192:193] op_sel_hi:[1,0]
    v_pk_mul_f32 v[226:227], v[210:211], v[192:193] op_sel_hi:[1,0]
    v_pk_mul_f32 v[234:235], v[218:219], v[192:193] op_sel_hi:[1,0]
    v_pk_mul_f32 v[228:229], v[212:213], v[192:193] op_sel_hi:[1,0]
    v_pk_mul_f32 v[236:237], v[220:221], v[192:193] op_sel_hi:[1,0]
    v_pk_mul_f32 v[230:231], v[214:215], v[192:193] op_sel_hi:[1,0]
    v_pk_mul_f32 v[238:239], v[222:223], v[192:193] op_sel_hi:[1,0]
    v_pk_fma_f32 v[224:225], v[216:217], v[194:195], v[224:225] op_sel_hi:[1,0,1] neg_lo:[0,1,0] neg_hi:[0,1,0]
    v_pk_fma_f32 v[232:233], v[208:209], v[194:195], v[232:233] op_sel_hi:[1,0,1]
    v_pk_fma_f32 v[226:227], v[218:219], v[194:195], v[226:227] op_sel_hi:[1,0,1] neg_lo:[0,1,0] neg_hi:[0,1,0]
    v_pk_fma_f32 v[234:235], v[210:211], v[194:195], v[234:235] op_sel_hi:[1,0,1]
    v_pk_fma_f32 v[228:229], v[220:221], v[194:195], v[228:229] op_sel_hi:[1,0,1] neg_lo:[0,1,0] neg_hi:[0,1,0]
    v_pk_fma_f32 v[236:237], v[212:213], v[194:195], v[236:237] op_sel_hi:[1,0,1]
    v_pk_fma_f32 v[230:231], v[222:223], v[194:195], v[230:231] op_sel_hi:[1,0,1] neg_lo:[0,1,0] neg_hi:[0,1,0]
    v_pk_fma_f32 v[238:239], v[214:215], v[194:195], v[238:239] op_sel_hi:[1,0,1]
    v_cvt_pk_bf16_f32 v80, v224, v225
    v_cvt_pk_bf16_f32 v84, v232, v233
    v_cvt_pk_bf16_f32 v81, v226, v227
    v_cvt_pk_bf16_f32 v85, v234, v235
    v_cvt_pk_bf16_f32 v82, v228, v229
    v_cvt_pk_bf16_f32 v86, v236, v237
    v_cvt_pk_bf16_f32 v83, v230, v231
    v_cvt_pk_bf16_f32 v87, v238, v239
    s_barrier
    ds_read_b128 v[160:163], v4 offset:0
    ds_read_b128 v[164:167], v4 offset:2048
    ds_read_b128 v[168:171], v4 offset:4096
    ds_read_b128 v[172:175], v4 offset:6144
    ds_read_b128 v[176:179], v5 offset:0
    ds_read_b128 v[180:183], v5 offset:2048
    ds_read_b128 v[184:187], v5 offset:4096
    ds_read_b128 v[188:191], v5 offset:6144
    v_mov_b32 v9, 0
    s_waitcnt lgkmcnt(4)
    v_mfma_f32_16x16x32_bf16 v[88:91], v[160:163], v[16:19], 0
    v_mfma_f32_16x16x32_bf16 v[92:95], v[160:163], v[20:23], 0
    ds_read_b128 v[192:195], v4 offset:8192
    ds_read_b128 v[196:199], v4 offset:10240
    ds_read_b128 v[200:203], v4 offset:12288
    ds_read_b128 v[204:207], v4 offset:14336
    v_mfma_f32_16x16x32_bf16 v[96:99], v[164:167], v[16:19], 0
    v_mfma_f32_16x16x32_bf16 v[100:103], v[164:167], v[20:23], 0
    v_mfma_f32_16x16x32_bf16 v[104:107], v[168:171], v[16:19], 0
    v_mfma_f32_16x16x32_bf16 v[108:111], v[168:171], v[20:23], 0
    v_mfma_f32_16x16x32_bf16 v[112:115], v[172:175], v[16:19], 0
    v_mfma_f32_16x16x32_bf16 v[116:119], v[172:175], v[20:23], 0
    v_mfma_f32_16x16x32_bf16 v[152:155], v[12:15], v[16:19], 0
    v_mfma_f32_16x16x32_bf16 v[156:159], v[12:15], v[20:23], 0
    s_waitcnt lgkmcnt(4)
    v_mfma_f32_16x16x32_bf16 v[88:91], v[176:179], v[24:27], v[88:91]
    v_mfma_f32_16x16x32_bf16 v[92:95], v[176:179], v[28:31], v[92:95]
    ds_read_b128 v[160:163], v5 offset:8192
    ds_read_b128 v[164:167], v5 offset:10240
    ds_read_b128 v[168:171], v5 offset:12288
    ds_read_b128 v[172:175], v5 offset:14336
    v_mfma_f32_16x16x32_bf16 v[96:99], v[180:183], v[24:27], v[96:99]
    v_mfma_f32_16x16x32_bf16 v[100:103], v[180:183], v[28:31], v[100:103]
    v_mfma_f32_16x16x32_bf16 v[104:107], v[184:187], v[24:27], v[104:107]
    v_mfma_f32_16x16x32_bf16 v[108:111], v[184:187], v[28:31], v[108:111]
    v_mfma_f32_16x16x32_bf16 v[112:115], v[188:191], v[24:27], v[112:115]
    v_mfma_f32_16x16x32_bf16 v[116:119], v[188:191], v[28:31], v[116:119]
    v_mfma_f32_16x16x32_bf16 v[152:155], v[12:15], v[24:27], v[152:155]
    v_mfma_f32_16x16x32_bf16 v[156:159], v[12:15], v[28:31], v[156:159]
    s_waitcnt lgkmcnt(4)
    v_mfma_f32_16x16x32_bf16 v[88:91], v[192:195], v[32:35], v[88:91]
    v_mfma_f32_16x16x32_bf16 v[92:95], v[192:195], v[36:39], v[92:95]
    s_barrier
    ds_read_b128 v[176:179], v4 offset:16384
    ds_read_b128 v[180:183], v4 offset:18432
    ds_read_b128 v[184:187], v4 offset:20480
    ds_read_b128 v[188:191], v4 offset:22528
    v_mfma_f32_16x16x32_bf16 v[96:99], v[196:199], v[32:35], v[96:99]
    v_mfma_f32_16x16x32_bf16 v[100:103], v[196:199], v[36:39], v[100:103]
    v_mfma_f32_16x16x32_bf16 v[104:107], v[200:203], v[32:35], v[104:107]
    v_mfma_f32_16x16x32_bf16 v[108:111], v[200:203], v[36:39], v[108:111]
    v_mfma_f32_16x16x32_bf16 v[112:115], v[204:207], v[32:35], v[112:115]
    v_mfma_f32_16x16x32_bf16 v[116:119], v[204:207], v[36:39], v[116:119]
    v_mfma_f32_16x16x32_bf16 v[152:155], v[12:15], v[32:35], v[152:155]
    v_mfma_f32_16x16x32_bf16 v[156:159], v[12:15], v[36:39], v[156:159]
    s_waitcnt lgkmcnt(4)
    v_mfma_f32_16x16x32_bf16 v[88:91], v[160:163], v[40:43], v[88:91]
    v_mfma_f32_16x16x32_bf16 v[92:95], v[160:163], v[44:47], v[92:95]
    ds_read_b128 v[192:195], v5 offset:16384
    ds_read_b128 v[196:199], v5 offset:18432
    ds_read_b128 v[200:203], v5 offset:20480
    ds_read_b128 v[204:207], v5 offset:22528
    v_mfma_f32_16x16x32_bf16 v[96:99], v[164:167], v[40:43], v[96:99]
    v_mfma_f32_16x16x32_bf16 v[100:103], v[164:167], v[44:47], v[100:103]
    v_mfma_f32_16x16x32_bf16 v[104:107], v[168:171], v[40:43], v[104:107]
    v_mfma_f32_16x16x32_bf16 v[108:111], v[168:171], v[44:47], v[108:111]
    v_mfma_f32_16x16x32_bf16 v[112:115], v[172:175], v[40:43], v[112:115]
    v_mfma_f32_16x16x32_bf16 v[116:119], v[172:175], v[44:47], v[116:119]
    v_mfma_f32_16x16x32_bf16 v[152:155], v[12:15], v[40:43], v[152:155]
    v_mfma_f32_16x16x32_bf16 v[156:159], v[12:15], v[44:47], v[156:159]
    s_waitcnt lgkmcnt(4)
    v_mfma_f32_16x16x32_bf16 v[88:91], v[176:179], v[48:51], v[88:91]
    v_mfma_f32_16x16x32_bf16 v[92:95], v[176:179], v[52:55], v[92:95]
    ds_read_b128 v[160:163], v4 offset:24576
    ds_read_b128 v[164:167], v4 offset:26624
    ds_read_b128 v[168:171], v4 offset:28672
    ds_read_b128 v[172:175], v4 offset:30720
    v_mfma_f32_16x16x32_bf16 v[96:99], v[180:183], v[48:51], v[96:99]
    v_mfma_f32_16x16x32_bf16 v[100:103], v[180:183], v[52:55], v[100:103]
    v_mfma_f32_16x16x32_bf16 v[104:107], v[184:187], v[48:51], v[104:107]
    v_mfma_f32_16x16x32_bf16 v[108:111], v[184:187], v[52:55], v[108:111]
    v_mfma_f32_16x16x32_bf16 v[112:115], v[188:191], v[48:51], v[112:115]
    v_mfma_f32_16x16x32_bf16 v[116:119], v[188:191], v[52:55], v[116:119]
    v_mfma_f32_16x16x32_bf16 v[152:155], v[12:15], v[48:51], v[152:155]
    v_mfma_f32_16x16x32_bf16 v[156:159], v[12:15], v[52:55], v[156:159]
    s_waitcnt lgkmcnt(4)
    v_mfma_f32_16x16x32_bf16 v[88:91], v[192:195], v[56:59], v[88:91]
    v_mfma_f32_16x16x32_bf16 v[92:95], v[192:195], v[60:63], v[92:95]
    ds_read_b128 v[176:179], v5 offset:24576
    ds_read_b128 v[180:183], v5 offset:26624
    ds_read_b128 v[184:187], v5 offset:28672
    ds_read_b128 v[188:191], v5 offset:30720
    v_mfma_f32_16x16x32_bf16 v[96:99], v[196:199], v[56:59], v[96:99]
    v_mfma_f32_16x16x32_bf16 v[100:103], v[196:199], v[60:63], v[100:103]
    v_mfma_f32_16x16x32_bf16 v[104:107], v[200:203], v[56:59], v[104:107]
    v_mfma_f32_16x16x32_bf16 v[108:111], v[200:203], v[60:63], v[108:111]
    v_mfma_f32_16x16x32_bf16 v[112:115], v[204:207], v[56:59], v[112:115]
    v_mfma_f32_16x16x32_bf16 v[116:119], v[204:207], v[60:63], v[116:119]
    v_mfma_f32_16x16x32_bf16 v[152:155], v[12:15], v[56:59], v[152:155]
    v_mfma_f32_16x16x32_bf16 v[156:159], v[12:15], v[60:63], v[156:159]
    s_waitcnt lgkmcnt(4)
    v_mfma_f32_16x16x32_bf16 v[88:91], v[160:163], v[64:67], v[88:91]
    v_mfma_f32_16x16x32_bf16 v[92:95], v[160:163], v[68:71], v[92:95]
    ds_read_b128 v[192:195], v4 offset:32768
    ds_read_b128 v[196:199], v4 offset:34816
    ds_read_b128 v[200:203], v4 offset:36864
    ds_read_b128 v[204:207], v4 offset:38912
    v_mfma_f32_16x16x32_bf16 v[96:99], v[164:167], v[64:67], v[96:99]
    v_mfma_f32_16x16x32_bf16 v[100:103], v[164:167], v[68:71], v[100:103]
    v_mfma_f32_16x16x32_bf16 v[104:107], v[168:171], v[64:67], v[104:107]
    v_mfma_f32_16x16x32_bf16 v[108:111], v[168:171], v[68:71], v[108:111]
    v_mfma_f32_16x16x32_bf16 v[112:115], v[172:175], v[64:67], v[112:115]
    v_mfma_f32_16x16x32_bf16 v[116:119], v[172:175], v[68:71], v[116:119]
    v_mfma_f32_16x16x32_bf16 v[152:155], v[12:15], v[64:67], v[152:155]
    v_mfma_f32_16x16x32_bf16 v[156:159], v[12:15], v[68:71], v[156:159]
    s_waitcnt lgkmcnt(4)
    v_mfma_f32_16x16x32_bf16 v[88:91], v[176:179], v[72:75], v[88:91]
    v_mfma_f32_16x16x32_bf16 v[92:95], v[176:179], v[76:79], v[92:95]
    ds_read_b128 v[160:163], v5 offset:32768
    ds_read_b128 v[164:167], v5 offset:34816
    ds_read_b128 v[168:171], v5 offset:36864
    ds_read_b128 v[172:175], v5 offset:38912
    v_mfma_f32_16x16x32_bf16 v[96:99], v[180:183], v[72:75], v[96:99]
    v_mfma_f32_16x16x32_bf16 v[100:103], v[180:183], v[76:79], v[100:103]
    v_mfma_f32_16x16x32_bf16 v[104:107], v[184:187], v[72:75], v[104:107]
    v_mfma_f32_16x16x32_bf16 v[108:111], v[184:187], v[76:79], v[108:111]
    v_mfma_f32_16x16x32_bf16 v[112:115], v[188:191], v[72:75], v[112:115]
    v_mfma_f32_16x16x32_bf16 v[116:119], v[188:191], v[76:79], v[116:119]
    v_mfma_f32_16x16x32_bf16 v[152:155], v[12:15], v[72:75], v[152:155]
    v_mfma_f32_16x16x32_bf16 v[156:159], v[12:15], v[76:79], v[156:159]
    s_waitcnt lgkmcnt(4)
    v_mfma_f32_16x16x32_bf16 v[88:91], v[192:195], v[80:83], v[88:91]
    v_mfma_f32_16x16x32_bf16 v[92:95], v[192:195], v[84:87], v[92:95]
    s_waitcnt vmcnt(0)
    s_barrier
    ds_read_b128 v[176:179], v4 offset:40960
    ds_read_b128 v[180:183], v4 offset:43008
    ds_read_b128 v[184:187], v4 offset:45056
    ds_read_b128 v[188:191], v4 offset:47104
    v_mfma_f32_16x16x32_bf16 v[96:99], v[196:199], v[80:83], v[96:99]
    v_mfma_f32_16x16x32_bf16 v[100:103], v[196:199], v[84:87], v[100:103]
    v_mfma_f32_16x16x32_bf16 v[104:107], v[200:203], v[80:83], v[104:107]
    v_mfma_f32_16x16x32_bf16 v[108:111], v[200:203], v[84:87], v[108:111]
    v_mfma_f32_16x16x32_bf16 v[112:115], v[204:207], v[80:83], v[112:115]
    v_mfma_f32_16x16x32_bf16 v[116:119], v[204:207], v[84:87], v[116:119]
    v_mfma_f32_16x16x32_bf16 v[152:155], v[12:15], v[80:83], v[152:155]
    v_mfma_f32_16x16x32_bf16 v[156:159], v[12:15], v[84:87], v[156:159]
    s_waitcnt lgkmcnt(4)
    v_mfma_f32_16x16x32_bf16 v[120:123], v[160:163], v[16:19], 0
    v_mfma_f32_16x16x32_bf16 v[124:127], v[160:163], v[20:23], 0
    ds_read_b128 v[192:195], v5 offset:40960
    ds_read_b128 v[196:199], v5 offset:43008
    ds_read_b128 v[200:203], v5 offset:45056
    ds_read_b128 v[204:207], v5 offset:47104
    v_mfma_f32_16x16x32_bf16 v[128:131], v[164:167], v[16:19], 0
    v_mfma_f32_16x16x32_bf16 v[132:135], v[164:167], v[20:23], 0
    v_mfma_f32_16x16x32_bf16 v[136:139], v[168:171], v[16:19], 0
    v_mfma_f32_16x16x32_bf16 v[140:143], v[168:171], v[20:23], 0
    v_mfma_f32_16x16x32_bf16 v[144:147], v[172:175], v[16:19], 0
    v_mfma_f32_16x16x32_bf16 v[148:151], v[172:175], v[20:23], 0
    s_waitcnt lgkmcnt(4)
    v_mfma_f32_16x16x32_bf16 v[120:123], v[176:179], v[24:27], v[120:123]
    v_mfma_f32_16x16x32_bf16 v[124:127], v[176:179], v[28:31], v[124:127]
    ds_read_b128 v[160:163], v4 offset:49152
    ds_read_b128 v[164:167], v4 offset:51200
    ds_read_b128 v[168:171], v4 offset:53248
    ds_read_b128 v[172:175], v4 offset:55296
    v_mfma_f32_16x16x32_bf16 v[128:131], v[180:183], v[24:27], v[128:131]
    v_mfma_f32_16x16x32_bf16 v[132:135], v[180:183], v[28:31], v[132:135]
    v_mfma_f32_16x16x32_bf16 v[136:139], v[184:187], v[24:27], v[136:139]
    v_mfma_f32_16x16x32_bf16 v[140:143], v[184:187], v[28:31], v[140:143]
    v_mfma_f32_16x16x32_bf16 v[144:147], v[188:191], v[24:27], v[144:147]
    v_mfma_f32_16x16x32_bf16 v[148:151], v[188:191], v[28:31], v[148:151]
    s_waitcnt lgkmcnt(4)
    v_mfma_f32_16x16x32_bf16 v[120:123], v[192:195], v[32:35], v[120:123]
    v_mfma_f32_16x16x32_bf16 v[124:127], v[192:195], v[36:39], v[124:127]
    ds_read_b128 v[176:179], v5 offset:49152
    ds_read_b128 v[180:183], v5 offset:51200
    ds_read_b128 v[184:187], v5 offset:53248
    ds_read_b128 v[188:191], v5 offset:55296
    v_mfma_f32_16x16x32_bf16 v[128:131], v[196:199], v[32:35], v[128:131]
    v_mfma_f32_16x16x32_bf16 v[132:135], v[196:199], v[36:39], v[132:135]
    v_mfma_f32_16x16x32_bf16 v[136:139], v[200:203], v[32:35], v[136:139]
    v_mfma_f32_16x16x32_bf16 v[140:143], v[200:203], v[36:39], v[140:143]
    v_mfma_f32_16x16x32_bf16 v[144:147], v[204:207], v[32:35], v[144:147]
    v_mfma_f32_16x16x32_bf16 v[148:151], v[204:207], v[36:39], v[148:151]
    s_waitcnt lgkmcnt(4)
    v_mfma_f32_16x16x32_bf16 v[120:123], v[160:163], v[40:43], v[120:123]
    v_mfma_f32_16x16x32_bf16 v[124:127], v[160:163], v[44:47], v[124:127]
    ds_read_b128 v[192:195], v4 offset:57344
    ds_read_b128 v[196:199], v4 offset:59392
    ds_read_b128 v[200:203], v4 offset:61440
    ds_read_b128 v[204:207], v4 offset:63488
    v_mfma_f32_16x16x32_bf16 v[128:131], v[164:167], v[40:43], v[128:131]
    v_mfma_f32_16x16x32_bf16 v[132:135], v[164:167], v[44:47], v[132:135]
    v_mfma_f32_16x16x32_bf16 v[136:139], v[168:171], v[40:43], v[136:139]
    v_mfma_f32_16x16x32_bf16 v[140:143], v[168:171], v[44:47], v[140:143]
    v_mfma_f32_16x16x32_bf16 v[144:147], v[172:175], v[40:43], v[144:147]
    v_mfma_f32_16x16x32_bf16 v[148:151], v[172:175], v[44:47], v[148:151]
    s_waitcnt lgkmcnt(4)
    v_mfma_f32_16x16x32_bf16 v[120:123], v[176:179], v[48:51], v[120:123]
    v_mfma_f32_16x16x32_bf16 v[124:127], v[176:179], v[52:55], v[124:127]
    ds_read_b128 v[160:163], v5 offset:57344
    ds_read_b128 v[164:167], v5 offset:59392
    ds_read_b128 v[168:171], v5 offset:61440
    ds_read_b128 v[172:175], v5 offset:63488
    v_mfma_f32_16x16x32_bf16 v[128:131], v[180:183], v[48:51], v[128:131]
    v_mfma_f32_16x16x32_bf16 v[132:135], v[180:183], v[52:55], v[132:135]
    v_mfma_f32_16x16x32_bf16 v[136:139], v[184:187], v[48:51], v[136:139]
    v_mfma_f32_16x16x32_bf16 v[140:143], v[184:187], v[52:55], v[140:143]
    v_mfma_f32_16x16x32_bf16 v[144:147], v[188:191], v[48:51], v[144:147]
    v_mfma_f32_16x16x32_bf16 v[148:151], v[188:191], v[52:55], v[148:151]
    s_waitcnt lgkmcnt(4)
    v_mfma_f32_16x16x32_bf16 v[120:123], v[192:195], v[56:59], v[120:123]
    v_mfma_f32_16x16x32_bf16 v[124:127], v[192:195], v[60:63], v[124:127]
    ds_read_b128 v[176:179], v242 offset:0
    ds_read_b128 v[180:183], v242 offset:2048
    ds_read_b128 v[184:187], v242 offset:4096
    ds_read_b128 v[188:191], v242 offset:6144
    v_mfma_f32_16x16x32_bf16 v[128:131], v[196:199], v[56:59], v[128:131]
    v_mfma_f32_16x16x32_bf16 v[132:135], v[196:199], v[60:63], v[132:135]
    v_mfma_f32_16x16x32_bf16 v[136:139], v[200:203], v[56:59], v[136:139]
    v_mfma_f32_16x16x32_bf16 v[140:143], v[200:203], v[60:63], v[140:143]
    v_mfma_f32_16x16x32_bf16 v[144:147], v[204:207], v[56:59], v[144:147]
    v_mfma_f32_16x16x32_bf16 v[148:151], v[204:207], v[60:63], v[148:151]
    s_waitcnt lgkmcnt(4)
    v_mfma_f32_16x16x32_bf16 v[120:123], v[160:163], v[64:67], v[120:123]
    v_mfma_f32_16x16x32_bf16 v[124:127], v[160:163], v[68:71], v[124:127]
    ds_read_b128 v[192:195], v243 offset:0
    ds_read_b128 v[196:199], v243 offset:2048
    ds_read_b128 v[200:203], v243 offset:4096
    ds_read_b128 v[204:207], v243 offset:6144
    v_mfma_f32_16x16x32_bf16 v[128:131], v[164:167], v[64:67], v[128:131]
    v_mfma_f32_16x16x32_bf16 v[132:135], v[164:167], v[68:71], v[132:135]
    v_mfma_f32_16x16x32_bf16 v[136:139], v[168:171], v[64:67], v[136:139]
    v_mfma_f32_16x16x32_bf16 v[140:143], v[168:171], v[68:71], v[140:143]
    v_mfma_f32_16x16x32_bf16 v[144:147], v[172:175], v[64:67], v[144:147]
    v_mfma_f32_16x16x32_bf16 v[148:151], v[172:175], v[68:71], v[148:151]
    s_waitcnt lgkmcnt(4)
    v_mfma_f32_16x16x32_bf16 v[120:123], v[176:179], v[72:75], v[120:123]
    v_mfma_f32_16x16x32_bf16 v[124:127], v[176:179], v[76:79], v[124:127]
    ds_read_b128 v[16:19], v246 offset:0
    ds_read_b128 v[24:27], v246 offset:1024
    v_mfma_f32_16x16x32_bf16 v[128:131], v[180:183], v[72:75], v[128:131]
    v_mfma_f32_16x16x32_bf16 v[132:135], v[180:183], v[76:79], v[132:135]
    ds_read_b128 v[32:35], v246 offset:2048
    ds_read_b128 v[40:43], v246 offset:3072
    v_mfma_f32_16x16x32_bf16 v[136:139], v[184:187], v[72:75], v[136:139]
    v_mfma_f32_16x16x32_bf16 v[140:143], v[184:187], v[76:79], v[140:143]
    ds_read_b128 v[48:51], v246 offset:4096
    ds_read_b128 v[56:59], v246 offset:5120
    v_mfma_f32_16x16x32_bf16 v[144:147], v[188:191], v[72:75], v[144:147]
    v_mfma_f32_16x16x32_bf16 v[148:151], v[188:191], v[76:79], v[148:151]
    ds_read_b128 v[64:67], v246 offset:6144
    ds_read_b128 v[20:23], v246 offset:7168
    s_waitcnt lgkmcnt(8)
    v_mfma_f32_16x16x32_bf16 v[120:123], v[192:195], v[80:83], v[120:123]
    v_mfma_f32_16x16x32_bf16 v[124:127], v[192:195], v[84:87], v[124:127]
    ds_read_b128 v[28:31], v246 offset:8192
    ds_read_b128 v[36:39], v246 offset:9216
    v_mfma_f32_16x16x32_bf16 v[128:131], v[196:199], v[80:83], v[128:131]
    v_mfma_f32_16x16x32_bf16 v[132:135], v[196:199], v[84:87], v[132:135]
    ds_read_b128 v[44:47], v246 offset:10240
    ds_read_b128 v[52:55], v246 offset:11264
    v_mfma_f32_16x16x32_bf16 v[136:139], v[200:203], v[80:83], v[136:139]
    v_mfma_f32_16x16x32_bf16 v[140:143], v[200:203], v[84:87], v[140:143]
    ds_read_b128 v[60:63], v246 offset:12288
    ds_read_b128 v[68:71], v246 offset:13312
    v_mfma_f32_16x16x32_bf16 v[144:147], v[204:207], v[80:83], v[144:147]
    v_mfma_f32_16x16x32_bf16 v[148:151], v[204:207], v[84:87], v[148:151]
    s_waitcnt lgkmcnt(0)
    ds_read_b128 v[248:251], v246 offset:14336
    ds_read_b128 v[252:255], v246 offset:15360
    v_pk_fma_f32 v[88:89], v[120:121], v[10:11], v[88:89]
    v_pk_fma_f32 v[90:91], v[122:123], v[10:11], v[90:91]
    v_pk_fma_f32 v[92:93], v[124:125], v[10:11], v[92:93]
    v_pk_fma_f32 v[94:95], v[126:127], v[10:11], v[94:95]
    v_pk_fma_f32 v[96:97], v[128:129], v[10:11], v[96:97]
    v_pk_fma_f32 v[98:99], v[130:131], v[10:11], v[98:99]
    v_pk_fma_f32 v[100:101], v[132:133], v[10:11], v[100:101]
    v_pk_fma_f32 v[102:103], v[134:135], v[10:11], v[102:103]
    v_pk_fma_f32 v[104:105], v[136:137], v[10:11], v[104:105]
    v_pk_fma_f32 v[106:107], v[138:139], v[10:11], v[106:107]
    v_pk_fma_f32 v[108:109], v[140:141], v[10:11], v[108:109]
    v_pk_fma_f32 v[110:111], v[142:143], v[10:11], v[110:111]
    v_pk_fma_f32 v[112:113], v[144:145], v[10:11], v[112:113]
    v_pk_fma_f32 v[114:115], v[146:147], v[10:11], v[114:115]
    v_pk_fma_f32 v[116:117], v[148:149], v[10:11], v[116:117]
    v_pk_fma_f32 v[118:119], v[150:151], v[10:11], v[118:119]
    s_waitcnt lgkmcnt(0)
    s_barrier
    ds_read_b128 v[208:211], v8 offset:0
    ds_read_b128 v[224:227], v8 offset:256
    ds_read_b128 v[212:215], v8 offset:64
    ds_read_b128 v[228:231], v8 offset:320
    ds_read_b128 v[216:219], v8 offset:128
    ds_read_b128 v[232:235], v8 offset:384
    ds_read_b128 v[220:223], v8 offset:192
    ds_read_b128 v[236:239], v8 offset:448
    s_waitcnt lgkmcnt(4)
    v_pk_mul_f32 v[184:185], v[224:225], v[152:153]
    v_pk_mul_f32 v[186:187], v[226:227], v[152:153]
    v_pk_mul_f32 v[188:189], v[224:225], v[156:157]
    v_pk_mul_f32 v[190:191], v[226:227], v[156:157]
    v_pk_mul_f32 v[192:193], v[228:229], v[152:153]
    v_pk_mul_f32 v[194:195], v[230:231], v[152:153]
    v_pk_mul_f32 v[196:197], v[228:229], v[156:157]
    v_pk_mul_f32 v[198:199], v[230:231], v[156:157]
    v_pk_fma_f32 v[88:89], v[208:209], v[88:89], v[184:185] neg_lo:[0,0,1] neg_hi:[0,0,1]
    v_pk_fma_f32 v[90:91], v[210:211], v[90:91], v[186:187] neg_lo:[0,0,1] neg_hi:[0,0,1]
    v_pk_fma_f32 v[92:93], v[208:209], v[92:93], v[188:189] neg_lo:[0,0,1] neg_hi:[0,0,1]
    v_pk_fma_f32 v[94:95], v[210:211], v[94:95], v[190:191] neg_lo:[0,0,1] neg_hi:[0,0,1]
    v_pk_fma_f32 v[96:97], v[212:213], v[96:97], v[192:193] neg_lo:[0,0,1] neg_hi:[0,0,1]
    v_pk_fma_f32 v[98:99], v[214:215], v[98:99], v[194:195] neg_lo:[0,0,1] neg_hi:[0,0,1]
    v_pk_fma_f32 v[100:101], v[212:213], v[100:101], v[196:197] neg_lo:[0,0,1] neg_hi:[0,0,1]
    v_pk_fma_f32 v[102:103], v[214:215], v[102:103], v[198:199] neg_lo:[0,0,1] neg_hi:[0,0,1]
    v_cvt_pk_bf16_f32 v160, v88, v89
    v_cvt_pk_bf16_f32 v161, v90, v91
    v_cvt_pk_bf16_f32 v162, v96, v97
    v_cvt_pk_bf16_f32 v163, v98, v99
    v_cvt_pk_bf16_f32 v168, v92, v93
    v_cvt_pk_bf16_f32 v169, v94, v95
    v_cvt_pk_bf16_f32 v170, v100, v101
    v_cvt_pk_bf16_f32 v171, v102, v103
    v_xor_b32 v176, 0x80008000, v168
    v_xor_b32 v177, 0x80008000, v169
    v_xor_b32 v178, 0x80008000, v170
    v_xor_b32 v179, 0x80008000, v171
    s_waitcnt lgkmcnt(0)
    v_mfma_f32_16x16x32_bf16 v[120:123], v[160:163], v[16:19], 0
    v_pk_mul_f32 v[184:185], v[232:233], v[152:153]
    v_pk_mul_f32 v[186:187], v[234:235], v[152:153]
    v_mfma_f32_16x16x32_bf16 v[124:127], v[160:163], v[24:27], 0
    v_pk_mul_f32 v[188:189], v[232:233], v[156:157]
    v_pk_mul_f32 v[190:191], v[234:235], v[156:157]
    v_mfma_f32_16x16x32_bf16 v[128:131], v[160:163], v[48:51], 0
    v_pk_mul_f32 v[192:193], v[236:237], v[152:153]
    v_pk_mul_f32 v[194:195], v[238:239], v[152:153]
    v_mfma_f32_16x16x32_bf16 v[132:135], v[160:163], v[56:59], 0
    v_pk_mul_f32 v[196:197], v[236:237], v[156:157]
    v_pk_mul_f32 v[198:199], v[238:239], v[156:157]
    v_mfma_f32_16x16x32_bf16 v[136:139], v[160:163], v[28:31], 0
    v_pk_fma_f32 v[104:105], v[216:217], v[104:105], v[184:185] neg_lo:[0,0,1] neg_hi:[0,0,1]
    v_pk_fma_f32 v[106:107], v[218:219], v[106:107], v[186:187] neg_lo:[0,0,1] neg_hi:[0,0,1]
    v_mfma_f32_16x16x32_bf16 v[140:143], v[160:163], v[36:39], 0
    v_pk_fma_f32 v[108:109], v[216:217], v[108:109], v[188:189] neg_lo:[0,0,1] neg_hi:[0,0,1]
    v_pk_fma_f32 v[110:111], v[218:219], v[110:111], v[190:191] neg_lo:[0,0,1] neg_hi:[0,0,1]
    v_mfma_f32_16x16x32_bf16 v[144:147], v[160:163], v[60:63], 0
    v_pk_fma_f32 v[112:113], v[220:221], v[112:113], v[192:193] neg_lo:[0,0,1] neg_hi:[0,0,1]
    v_pk_fma_f32 v[114:115], v[222:223], v[114:115], v[194:195] neg_lo:[0,0,1] neg_hi:[0,0,1]
    v_mfma_f32_16x16x32_bf16 v[148:151], v[160:163], v[68:71], 0
    v_pk_fma_f32 v[116:117], v[220:221], v[116:117], v[196:197] neg_lo:[0,0,1] neg_hi:[0,0,1]
    v_pk_fma_f32 v[118:119], v[222:223], v[118:119], v[198:199] neg_lo:[0,0,1] neg_hi:[0,0,1]
    v_mfma_f32_16x16x32_bf16 v[120:123], v[176:179], v[24:27], v[120:123]
    v_cvt_pk_bf16_f32 v164, v104, v105
    v_cvt_pk_bf16_f32 v165, v106, v107
    v_mfma_f32_16x16x32_bf16 v[124:127], v[168:171], v[16:19], v[124:127]
    v_cvt_pk_bf16_f32 v166, v112, v113
    v_cvt_pk_bf16_f32 v167, v114, v115
    v_mfma_f32_16x16x32_bf16 v[128:131], v[176:179], v[56:59], v[128:131]
    v_cvt_pk_bf16_f32 v172, v108, v109
    v_cvt_pk_bf16_f32 v173, v110, v111
    v_mfma_f32_16x16x32_bf16 v[132:135], v[168:171], v[48:51], v[132:135]
    v_cvt_pk_bf16_f32 v174, v116, v117
    v_cvt_pk_bf16_f32 v175, v118, v119
    v_mfma_f32_16x16x32_bf16 v[136:139], v[176:179], v[36:39], v[136:139]
    v_xor_b32 v180, 0x80008000, v172
    v_xor_b32 v181, 0x80008000, v173
    v_mfma_f32_16x16x32_bf16 v[140:143], v[168:171], v[28:31], v[140:143]
    v_xor_b32 v182, 0x80008000, v174
    v_xor_b32 v183, 0x80008000, v175
    v_mfma_f32_16x16x32_bf16 v[144:147], v[176:179], v[68:71], v[144:147]
    v_mfma_f32_16x16x32_bf16 v[148:151], v[168:171], v[60:63], v[148:151]
    v_mfma_f32_16x16x32_bf16 v[120:123], v[164:167], v[32:35], v[120:123]
    v_mfma_f32_16x16x32_bf16 v[124:127], v[164:167], v[40:43], v[124:127]
    v_mfma_f32_16x16x32_bf16 v[120:123], v[180:183], v[40:43], v[120:123]
    v_mfma_f32_16x16x32_bf16 v[124:127], v[172:175], v[32:35], v[124:127]
    v_mfma_f32_16x16x32_bf16 v[128:131], v[164:167], v[64:67], v[128:131]
    v_mfma_f32_16x16x32_bf16 v[132:135], v[164:167], v[20:23], v[132:135]
    v_mfma_f32_16x16x32_bf16 v[128:131], v[180:183], v[20:23], v[128:131]
    v_mfma_f32_16x16x32_bf16 v[132:135], v[172:175], v[64:67], v[132:135]
    v_mfma_f32_16x16x32_bf16 v[136:139], v[164:167], v[44:47], v[136:139]
    v_mfma_f32_16x16x32_bf16 v[140:143], v[164:167], v[52:55], v[140:143]
    v_mfma_f32_16x16x32_bf16 v[136:139], v[180:183], v[52:55], v[136:139]
    v_mfma_f32_16x16x32_bf16 v[140:143], v[172:175], v[44:47], v[140:143]
    v_cvt_pk_bf16_f32 v184, v120, v121
    v_cvt_pk_bf16_f32 v185, v122, v123
    v_cvt_pk_bf16_f32 v186, v124, v125
    v_cvt_pk_bf16_f32 v187, v126, v127
    ds_write_b128 v240, v[184:187] offset:0
    ds_read_b128 v[208:211], v241 offset:0
    v_mfma_f32_16x16x32_bf16 v[144:147], v[164:167], v[248:251], v[144:147]
    v_mfma_f32_16x16x32_bf16 v[148:151], v[164:167], v[252:255], v[148:151]
    v_mfma_f32_16x16x32_bf16 v[144:147], v[180:183], v[252:255], v[144:147]
    v_mfma_f32_16x16x32_bf16 v[148:151], v[172:175], v[248:251], v[148:151]
    v_cvt_pk_bf16_f32 v188, v128, v129
    v_cvt_pk_bf16_f32 v189, v130, v131
    v_cvt_pk_bf16_f32 v190, v132, v133
    v_cvt_pk_bf16_f32 v191, v134, v135
    ds_write_b128 v240, v[188:191] offset:1024
    ds_read_b128 v[212:215], v241 offset:1024
    v_cvt_pk_bf16_f32 v192, v136, v137
    v_cvt_pk_bf16_f32 v193, v138, v139
    v_cvt_pk_bf16_f32 v194, v140, v141
    v_cvt_pk_bf16_f32 v195, v142, v143
    ds_write_b128 v240, v[192:195] offset:2048
    ds_read_b128 v[216:219], v241 offset:2048
    s_waitcnt lgkmcnt(4)
    buffer_store_dwordx4 v[208:211], v7, s[36:39], 0 offen sc1
    v_cvt_pk_bf16_f32 v196, v144, v145
    v_cvt_pk_bf16_f32 v197, v146, v147
    v_cvt_pk_bf16_f32 v198, v148, v149
    v_cvt_pk_bf16_f32 v199, v150, v151
    ds_write_b128 v240, v[196:199] offset:3072
    ds_read_b128 v[220:223], v241 offset:3072
    s_waitcnt lgkmcnt(4)
    buffer_store_dwordx4 v[212:215], v7, s[36:39], s60 offen sc1
    s_waitcnt lgkmcnt(2)
    buffer_store_dwordx4 v[216:219], v7, s[36:39], s61 offen sc1
    s_waitcnt lgkmcnt(0)
    buffer_store_dwordx4 v[220:223], v7, s[36:39], s62 offen sc1
L_ARRIVE:
    v_mov_b32 v10, 156224
    v_mov_b32 v11, 1
    v_mov_b32 v9, 0
    s_sub_u32 s49, s2, 64
    s_lshl_b32 s49, s49, 6
    s_add_u32 s49, s49, 2375680
    s_mov_b32 s36, s14
    s_mov_b32 s37, s15
    s_mov_b32 s38, 9437184
    s_mov_b32 s39, 0x00020000
    s_waitcnt vmcnt(0)
    s_mov_b64 exec, 1
    ds_add_rtn_u32 v6, v10, v11
    s_waitcnt lgkmcnt(0)
    v_readfirstlane_b32 s59, v6
    s_nop 0
    s_cmp_lg_u32 s59, 3
    s_cbranch_scc1 L_NOFLAG
    buffer_store_dword v9, v9, s[36:39], s49 offen sc1
L_NOFLAG:
    s_mov_b64 exec, -1
    s_cmp_lt_u32 s2, 128
    s_cbranch_scc1 L_P2
    s_barrier
    s_setprio 0
    s_branch L_ROWP
L_STATS:
    v_and_b32 v8, 3, v2
    v_lshrrev_b32 v9, 2, v2
    v_sub_u32 v9, v9, v3
    v_and_b32 v9, 3, v9
    v_cmp_eq_u32 s[44:45], 1, v8
    v_cmp_eq_u32 s[50:51], 1, v9
    v_cmp_eq_u32 s[46:47], 2, v8
    v_cmp_eq_u32 s[52:53], 2, v9
    v_cmp_eq_u32 s[48:49], 3, v8
    v_cmp_eq_u32 s[54:55], 3, v9
    v_lshlrev_b32 v10, 4, v9
    v_lshl_add_u32 v10, v3, 2, v10
    v_add_u32 v10, v10, v8
    v_lshlrev_b32 v10, 2, v10
    v_add_u32 v10, 151552, v10
    s_cmp_eq_u32 s43, 0
    s_cselect_b32 s56, 2.0, 0
    v_mov_b32 v8, 156224
    v_mov_b32 v9, 0
    ds_write_b32 v8, v9
    s_waitcnt lgkmcnt(0)
    s_barrier
    ds_read_b128 v[48:51], v4 offset:0
    ds_read_b128 v[52:55], v4 offset:2048
    ds_read_b128 v[56:59], v4 offset:4096
    ds_read_b128 v[60:63], v4 offset:6144
    ds_read_b128 v[64:67], v5 offset:0
    ds_read_b128 v[68:71], v5 offset:2048
    ds_read_b128 v[72:75], v5 offset:4096
    ds_read_b128 v[76:79], v5 offset:6144
    s_waitcnt lgkmcnt(4)
    v_mfma_f32_16x16x32_bf16 v[16:19], v[48:51], v[48:51], 0
    v_mfma_f32_16x16x32_bf16 v[32:35], v[12:15], v[48:51], 0
    ds_read_b128 v[80:83], v4 offset:8192
    ds_read_b128 v[84:87], v4 offset:10240
    ds_read_b128 v[88:91], v4 offset:12288
    ds_read_b128 v[92:95], v4 offset:14336
    v_mfma_f32_16x16x32_bf16 v[20:23], v[52:55], v[52:55], 0
    v_mfma_f32_16x16x32_bf16 v[36:39], v[12:15], v[52:55], 0
    v_mfma_f32_16x16x32_bf16 v[24:27], v[56:59], v[56:59], 0
    v_mfma_f32_16x16x32_bf16 v[40:43], v[12:15], v[56:59], 0
    v_mfma_f32_16x16x32_bf16 v[28:31], v[60:63], v[60:63], 0
    v_mfma_f32_16x16x32_bf16 v[44:47], v[12:15], v[60:63], 0
    s_waitcnt lgkmcnt(4)
    v_mfma_f32_16x16x32_bf16 v[16:19], v[64:67], v[64:67], v[16:19]
    v_mfma_f32_16x16x32_bf16 v[32:35], v[12:15], v[64:67], v[32:35]
    ds_read_b128 v[48:51], v5 offset:8192
    ds_read_b128 v[52:55], v5 offset:10240
    ds_read_b128 v[56:59], v5 offset:12288
    ds_read_b128 v[60:63], v5 offset:14336
    v_mfma_f32_16x16x32_bf16 v[20:23], v[68:71], v[68:71], v[20:23]
    v_mfma_f32_16x16x32_bf16 v[36:39], v[12:15], v[68:71], v[36:39]
    v_mfma_f32_16x16x32_bf16 v[24:27], v[72:75], v[72:75], v[24:27]
    v_mfma_f32_16x16x32_bf16 v[40:43], v[12:15], v[72:75], v[40:43]
    v_mfma_f32_16x16x32_bf16 v[28:31], v[76:79], v[76:79], v[28:31]
    v_mfma_f32_16x16x32_bf16 v[44:47], v[12:15], v[76:79], v[44:47]
    s_waitcnt lgkmcnt(4)
    v_mfma_f32_16x16x32_bf16 v[16:19], v[80:83], v[80:83], v[16:19]
    v_mfma_f32_16x16x32_bf16 v[32:35], v[12:15], v[80:83], v[32:35]
    s_barrier
    ds_read_b128 v[64:67], v4 offset:16384
    ds_read_b128 v[68:71], v4 offset:18432
    ds_read_b128 v[72:75], v4 offset:20480
    ds_read_b128 v[76:79], v4 offset:22528
    v_mfma_f32_16x16x32_bf16 v[20:23], v[84:87], v[84:87], v[20:23]
    v_mfma_f32_16x16x32_bf16 v[36:39], v[12:15], v[84:87], v[36:39]
    v_mfma_f32_16x16x32_bf16 v[24:27], v[88:91], v[88:91], v[24:27]
    v_mfma_f32_16x16x32_bf16 v[40:43], v[12:15], v[88:91], v[40:43]
    v_mfma_f32_16x16x32_bf16 v[28:31], v[92:95], v[92:95], v[28:31]
    v_mfma_f32_16x16x32_bf16 v[44:47], v[12:15], v[92:95], v[44:47]
    s_waitcnt lgkmcnt(4)
    v_mfma_f32_16x16x32_bf16 v[16:19], v[48:51], v[48:51], v[16:19]
    v_mfma_f32_16x16x32_bf16 v[32:35], v[12:15], v[48:51], v[32:35]
    ds_read_b128 v[80:83], v5 offset:16384
    ds_read_b128 v[84:87], v5 offset:18432
    ds_read_b128 v[88:91], v5 offset:20480
    ds_read_b128 v[92:95], v5 offset:22528
    v_mfma_f32_16x16x32_bf16 v[20:23], v[52:55], v[52:55], v[20:23]
    v_mfma_f32_16x16x32_bf16 v[36:39], v[12:15], v[52:55], v[36:39]
    v_mfma_f32_16x16x32_bf16 v[24:27], v[56:59], v[56:59], v[24:27]
    v_mfma_f32_16x16x32_bf16 v[40:43], v[12:15], v[56:59], v[40:43]
    v_mfma_f32_16x16x32_bf16 v[28:31], v[60:63], v[60:63], v[28:31]
    v_mfma_f32_16x16x32_bf16 v[44:47], v[12:15], v[60:63], v[44:47]
    s_waitcnt lgkmcnt(4)
    v_mfma_f32_16x16x32_bf16 v[16:19], v[64:67], v[64:67], v[16:19]
    v_mfma_f32_16x16x32_bf16 v[32:35], v[12:15], v[64:67], v[32:35]
    ds_read_b128 v[48:51], v4 offset:24576
    ds_read_b128 v[52:55], v4 offset:26624
    ds_read_b128 v[56:59], v4 offset:28672
    ds_read_b128 v[60:63], v4 offset:30720
    v_mfma_f32_16x16x32_bf16 v[20:23], v[68:71], v[68:71], v[20:23]
    v_mfma_f32_16x16x32_bf16 v[36:39], v[12:15], v[68:71], v[36:39]
    v_mfma_f32_16x16x32_bf16 v[24:27], v[72:75], v[72:75], v[24:27]
    v_mfma_f32_16x16x32_bf16 v[40:43], v[12:15], v[72:75], v[40:43]
    v_mfma_f32_16x16x32_bf16 v[28:31], v[76:79], v[76:79], v[28:31]
    v_mfma_f32_16x16x32_bf16 v[44:47], v[12:15], v[76:79], v[44:47]
    s_waitcnt lgkmcnt(4)
    v_mfma_f32_16x16x32_bf16 v[16:19], v[80:83], v[80:83], v[16:19]
    v_mfma_f32_16x16x32_bf16 v[32:35], v[12:15], v[80:83], v[32:35]
    ds_read_b128 v[64:67], v5 offset:24576
    ds_read_b128 v[68:71], v5 offset:26624
    ds_read_b128 v[72:75], v5 offset:28672
    ds_read_b128 v[76:79], v5 offset:30720
    v_mfma_f32_16x16x32_bf16 v[20:23], v[84:87], v[84:87], v[20:23]
    v_mfma_f32_16x16x32_bf16 v[36:39], v[12:15], v[84:87], v[36:39]
    v_mfma_f32_16x16x32_bf16 v[24:27], v[88:91], v[88:91], v[24:27]
    v_mfma_f32_16x16x32_bf16 v[40:43], v[12:15], v[88:91], v[40:43]
    v_mfma_f32_16x16x32_bf16 v[28:31], v[92:95], v[92:95], v[28:31]
    v_mfma_f32_16x16x32_bf16 v[44:47], v[12:15], v[92:95], v[44:47]
    s_waitcnt lgkmcnt(4)
    v_mfma_f32_16x16x32_bf16 v[16:19], v[48:51], v[48:51], v[16:19]
    v_mfma_f32_16x16x32_bf16 v[32:35], v[12:15], v[48:51], v[32:35]
    ds_read_b128 v[80:83], v4 offset:32768
    ds_read_b128 v[84:87], v4 offset:34816
    ds_read_b128 v[88:91], v4 offset:36864
    ds_read_b128 v[92:95], v4 offset:38912
    v_mfma_f32_16x16x32_bf16 v[20:23], v[52:55], v[52:55], v[20:23]
    v_mfma_f32_16x16x32_bf16 v[36:39], v[12:15], v[52:55], v[36:39]
    v_mfma_f32_16x16x32_bf16 v[24:27], v[56:59], v[56:59], v[24:27]
    v_mfma_f32_16x16x32_bf16 v[40:43], v[12:15], v[56:59], v[40:43]
    v_mfma_f32_16x16x32_bf16 v[28:31], v[60:63], v[60:63], v[28:31]
    v_mfma_f32_16x16x32_bf16 v[44:47], v[12:15], v[60:63], v[44:47]
    s_waitcnt lgkmcnt(4)
    v_mfma_f32_16x16x32_bf16 v[16:19], v[64:67], v[64:67], v[16:19]
    v_mfma_f32_16x16x32_bf16 v[32:35], v[12:15], v[64:67], v[32:35]
    ds_read_b128 v[48:51], v5 offset:32768
    ds_read_b128 v[52:55], v5 offset:34816
    ds_read_b128 v[56:59], v5 offset:36864
    ds_read_b128 v[60:63], v5 offset:38912
    v_mfma_f32_16x16x32_bf16 v[20:23], v[68:71], v[68:71], v[20:23]
    v_mfma_f32_16x16x32_bf16 v[36:39], v[12:15], v[68:71], v[36:39]
    v_mfma_f32_16x16x32_bf16 v[24:27], v[72:75], v[72:75], v[24:27]
    v_mfma_f32_16x16x32_bf16 v[40:43], v[12:15], v[72:75], v[40:43]
    v_mfma_f32_16x16x32_bf16 v[28:31], v[76:79], v[76:79], v[28:31]
    v_mfma_f32_16x16x32_bf16 v[44:47], v[12:15], v[76:79], v[44:47]
    s_waitcnt lgkmcnt(4)
    v_mfma_f32_16x16x32_bf16 v[16:19], v[80:83], v[80:83], v[16:19]
    v_mfma_f32_16x16x32_bf16 v[32:35], v[12:15], v[80:83], v[32:35]
    s_waitcnt vmcnt(0)
    s_barrier
    ds_read_b128 v[64:67], v4 offset:40960
    ds_read_b128 v[68:71], v4 offset:43008
    ds_read_b128 v[72:75], v4 offset:45056
    ds_read_b128 v[76:79], v4 offset:47104
    v_mfma_f32_16x16x32_bf16 v[20:23], v[84:87], v[84:87], v[20:23]
    v_mfma_f32_16x16x32_bf16 v[36:39], v[12:15], v[84:87], v[36:39]
    v_mfma_f32_16x16x32_bf16 v[24:27], v[88:91], v[88:91], v[24:27]
    v_mfma_f32_16x16x32_bf16 v[40:43], v[12:15], v[88:91], v[40:43]
    v_mfma_f32_16x16x32_bf16 v[28:31], v[92:95], v[92:95], v[28:31]
    v_mfma_f32_16x16x32_bf16 v[44:47], v[12:15], v[92:95], v[44:47]
    s_waitcnt lgkmcnt(4)
    v_mfma_f32_16x16x32_bf16 v[16:19], v[48:51], v[48:51], v[16:19]
    v_mfma_f32_16x16x32_bf16 v[32:35], v[12:15], v[48:51], v[32:35]
    ds_read_b128 v[80:83], v5 offset:40960
    ds_read_b128 v[84:87], v5 offset:43008
    ds_read_b128 v[88:91], v5 offset:45056
    ds_read_b128 v[92:95], v5 offset:47104
    v_mfma_f32_16x16x32_bf16 v[20:23], v[52:55], v[52:55], v[20:23]
    v_mfma_f32_16x16x32_bf16 v[36:39], v[12:15], v[52:55], v[36:39]
    v_mfma_f32_16x16x32_bf16 v[24:27], v[56:59], v[56:59], v[24:27]
    v_mfma_f32_16x16x32_bf16 v[40:43], v[12:15], v[56:59], v[40:43]
    v_mfma_f32_16x16x32_bf16 v[28:31], v[60:63], v[60:63], v[28:31]
    v_mfma_f32_16x16x32_bf16 v[44:47], v[12:15], v[60:63], v[44:47]
    s_waitcnt lgkmcnt(4)
    v_mfma_f32_16x16x32_bf16 v[16:19], v[64:67], v[64:67], v[16:19]
    v_mfma_f32_16x16x32_bf16 v[32:35], v[12:15], v[64:67], v[32:35]
    ds_read_b128 v[48:51], v4 offset:49152
    ds_read_b128 v[52:55], v4 offset:51200
    ds_read_b128 v[56:59], v4 offset:53248
    ds_read_b128 v[60:63], v4 offset:55296
    v_mfma_f32_16x16x32_bf16 v[20:23], v[68:71], v[68:71], v[20:23]
    v_mfma_f32_16x16x32_bf16 v[36:39], v[12:15], v[68:71], v[36:39]
    v_mfma_f32_16x16x32_bf16 v[24:27], v[72:75], v[72:75], v[24:27]
    v_mfma_f32_16x16x32_bf16 v[40:43], v[12:15], v[72:75], v[40:43]
    v_mfma_f32_16x16x32_bf16 v[28:31], v[76:79], v[76:79], v[28:31]
    v_mfma_f32_16x16x32_bf16 v[44:47], v[12:15], v[76:79], v[44:47]
    s_waitcnt lgkmcnt(4)
    v_mfma_f32_16x16x32_bf16 v[16:19], v[80:83], v[80:83], v[16:19]
    v_mfma_f32_16x16x32_bf16 v[32:35], v[12:15], v[80:83], v[32:35]
    ds_read_b128 v[64:67], v5 offset:49152
    ds_read_b128 v[68:71], v5 offset:51200
    ds_read_b128 v[72:75], v5 offset:53248
    ds_read_b128 v[76:79], v5 offset:55296
    v_mfma_f32_16x16x32_bf16 v[20:23], v[84:87], v[84:87], v[20:23]
    v_mfma_f32_16x16x32_bf16 v[36:39], v[12:15], v[84:87], v[36:39]
    v_mfma_f32_16x16x32_bf16 v[24:27], v[88:91], v[88:91], v[24:27]
    v_mfma_f32_16x16x32_bf16 v[40:43], v[12:15], v[88:91], v[40:43]
    v_mfma_f32_16x16x32_bf16 v[28:31], v[92:95], v[92:95], v[28:31]
    v_mfma_f32_16x16x32_bf16 v[44:47], v[12:15], v[92:95], v[44:47]
    s_waitcnt lgkmcnt(4)
    v_mfma_f32_16x16x32_bf16 v[16:19], v[48:51], v[48:51], v[16:19]
    v_mfma_f32_16x16x32_bf16 v[32:35], v[12:15], v[48:51], v[32:35]
    ds_read_b128 v[80:83], v4 offset:57344
    ds_read_b128 v[84:87], v4 offset:59392
    ds_read_b128 v[88:91], v4 offset:61440
    ds_read_b128 v[92:95], v4 offset:63488
    v_mfma_f32_16x16x32_bf16 v[20:23], v[52:55], v[52:55], v[20:23]
    v_mfma_f32_16x16x32_bf16 v[36:39], v[12:15], v[52:55], v[36:39]
    v_mfma_f32_16x16x32_bf16 v[24:27], v[56:59], v[56:59], v[24:27]
    v_mfma_f32_16x16x32_bf16 v[40:43], v[12:15], v[56:59], v[40:43]
    v_mfma_f32_16x16x32_bf16 v[28:31], v[60:63], v[60:63], v[28:31]
    v_mfma_f32_16x16x32_bf16 v[44:47], v[12:15], v[60:63], v[44:47]
    s_waitcnt lgkmcnt(4)
    v_mfma_f32_16x16x32_bf16 v[16:19], v[64:67], v[64:67], v[16:19]
    v_mfma_f32_16x16x32_bf16 v[32:35], v[12:15], v[64:67], v[32:35]
    ds_read_b128 v[48:51], v5 offset:57344
    ds_read_b128 v[52:55], v5 offset:59392
    ds_read_b128 v[56:59], v5 offset:61440
    ds_read_b128 v[60:63], v5 offset:63488
    v_mfma_f32_16x16x32_bf16 v[20:23], v[68:71], v[68:71], v[20:23]
    v_mfma_f32_16x16x32_bf16 v[36:39], v[12:15], v[68:71], v[36:39]
    v_mfma_f32_16x16x32_bf16 v[24:27], v[72:75], v[72:75], v[24:27]
    v_mfma_f32_16x16x32_bf16 v[40:43], v[12:15], v[72:75], v[40:43]
    v_mfma_f32_16x16x32_bf16 v[28:31], v[76:79], v[76:79], v[28:31]
    v_mfma_f32_16x16x32_bf16 v[44:47], v[12:15], v[76:79], v[44:47]
    s_waitcnt lgkmcnt(4)
    v_mfma_f32_16x16x32_bf16 v[16:19], v[80:83], v[80:83], v[16:19]
    v_mfma_f32_16x16x32_bf16 v[32:35], v[12:15], v[80:83], v[32:35]
    ds_read_b128 v[64:67], v242 offset:0
    ds_read_b128 v[68:71], v242 offset:2048
    ds_read_b128 v[72:75], v242 offset:4096
    ds_read_b128 v[76:79], v242 offset:6144
    v_mfma_f32_16x16x32_bf16 v[20:23], v[84:87], v[84:87], v[20:23]
    v_mfma_f32_16x16x32_bf16 v[36:39], v[12:15], v[84:87], v[36:39]
    v_mfma_f32_16x16x32_bf16 v[24:27], v[88:91], v[88:91], v[24:27]
    v_mfma_f32_16x16x32_bf16 v[40:43], v[12:15], v[88:91], v[40:43]
    v_mfma_f32_16x16x32_bf16 v[28:31], v[92:95], v[92:95], v[28:31]
    v_mfma_f32_16x16x32_bf16 v[44:47], v[12:15], v[92:95], v[44:47]
    s_waitcnt lgkmcnt(4)
    v_mfma_f32_16x16x32_bf16 v[16:19], v[48:51], v[48:51], v[16:19]
    v_mfma_f32_16x16x32_bf16 v[32:35], v[12:15], v[48:51], v[32:35]
    ds_read_b128 v[80:83], v243 offset:0
    ds_read_b128 v[84:87], v243 offset:2048
    ds_read_b128 v[88:91], v243 offset:4096
    ds_read_b128 v[92:95], v243 offset:6144
    v_mfma_f32_16x16x32_bf16 v[20:23], v[52:55], v[52:55], v[20:23]
    v_mfma_f32_16x16x32_bf16 v[36:39], v[12:15], v[52:55], v[36:39]
    v_mfma_f32_16x16x32_bf16 v[24:27], v[56:59], v[56:59], v[24:27]
    v_mfma_f32_16x16x32_bf16 v[40:43], v[12:15], v[56:59], v[40:43]
    v_mfma_f32_16x16x32_bf16 v[28:31], v[60:63], v[60:63], v[28:31]
    v_mfma_f32_16x16x32_bf16 v[44:47], v[12:15], v[60:63], v[44:47]
    s_waitcnt lgkmcnt(4)
    v_mfma_f32_16x16x32_bf16 v[16:19], v[64:67], v[64:67], v[16:19]
    v_mfma_f32_16x16x32_bf16 v[32:35], v[12:15], v[64:67], v[32:35]
    v_mfma_f32_16x16x32_bf16 v[20:23], v[68:71], v[68:71], v[20:23]
    v_mfma_f32_16x16x32_bf16 v[36:39], v[12:15], v[68:71], v[36:39]
    v_mfma_f32_16x16x32_bf16 v[24:27], v[72:75], v[72:75], v[24:27]
    v_mfma_f32_16x16x32_bf16 v[40:43], v[12:15], v[72:75], v[40:43]
    v_mfma_f32_16x16x32_bf16 v[28:31], v[76:79], v[76:79], v[28:31]
    v_mfma_f32_16x16x32_bf16 v[44:47], v[12:15], v[76:79], v[44:47]
    s_waitcnt lgkmcnt(0)
    v_mfma_f32_16x16x32_bf16 v[16:19], v[80:83], v[80:83], v[16:19]
    v_mfma_f32_16x16x32_bf16 v[32:35], v[12:15], v[80:83], v[32:35]
    v_mfma_f32_16x16x32_bf16 v[20:23], v[84:87], v[84:87], v[20:23]
    v_mfma_f32_16x16x32_bf16 v[36:39], v[12:15], v[84:87], v[36:39]
    v_mfma_f32_16x16x32_bf16 v[24:27], v[88:91], v[88:91], v[24:27]
    v_mfma_f32_16x16x32_bf16 v[40:43], v[12:15], v[88:91], v[40:43]
    v_mfma_f32_16x16x32_bf16 v[28:31], v[92:95], v[92:95], v[28:31]
    v_mfma_f32_16x16x32_bf16 v[44:47], v[12:15], v[92:95], v[44:47]
    s_nop 0
    v_cndmask_b32 v16, v16, v17, s[44:45]
    v_cndmask_b32 v16, v16, v18, s[46:47]
    v_cndmask_b32 v16, v16, v19, s[48:49]
    v_cndmask_b32 v20, v20, v21, s[44:45]
    v_cndmask_b32 v20, v20, v22, s[46:47]
    v_cndmask_b32 v20, v20, v23, s[48:49]
    v_cndmask_b32 v24, v24, v25, s[44:45]
    v_cndmask_b32 v24, v24, v26, s[46:47]
    v_cndmask_b32 v24, v24, v27, s[48:49]
    v_cndmask_b32 v28, v28, v29, s[44:45]
    v_cndmask_b32 v28, v28, v30, s[46:47]
    v_cndmask_b32 v28, v28, v31, s[48:49]
    v_mov_b32_dpp v21, v20 row_ror:4 row_mask:0xf bank_mask:0xf
    v_mov_b32_dpp v37, v36 row_ror:4 row_mask:0xf bank_mask:0xf
    v_mov_b32_dpp v25, v24 row_ror:8 row_mask:0xf bank_mask:0xf
    v_mov_b32_dpp v41, v40 row_ror:8 row_mask:0xf bank_mask:0xf
    v_mov_b32_dpp v29, v28 row_ror:12 row_mask:0xf bank_mask:0xf
    v_mov_b32_dpp v45, v44 row_ror:12 row_mask:0xf bank_mask:0xf
    v_cndmask_b32 v16, v16, v21, s[50:51]
    v_cndmask_b32 v32, v32, v37, s[50:51]
    v_cndmask_b32 v16, v16, v25, s[52:53]
    v_cndmask_b32 v32, v32, v41, s[52:53]
    v_cndmask_b32 v16, v16, v29, s[54:55]
    v_cndmask_b32 v32, v32, v45, s[54:55]
    v_mul_f32 v32, 0x3ae38e39, v32
    v_mul_f32 v16, 0x3ae38e39, v16
    v_fma_f32 v16, -v32, v32, v16
    v_max_f32 v16, 0, v16
    v_cvt_pk_bf16_f32 v16, v16, v16
    v_and_b32 v16, 0xffff0000, v16
    v_add_f32 v16, 0x3727c5ac, v16
    v_cvt_pk_bf16_f32 v16, v16, v16
    v_and_b32 v16, 0xffff0000, v16
    v_sqrt_f32 v16, v16
    v_mul_f32 v32, s56, v32
    v_cvt_pk_bf16_f32 v16, v16, v16
    v_and_b32 v16, 0xffff0000, v16
    v_rcp_f32 v16, v16
    s_nop 0
    v_mul_f32 v32, v32, v16
    ds_write_b32 v10, v16
    ds_write_b32 v10, v32 offset:256
    s_waitcnt lgkmcnt(0)
    s_barrier
    s_mov_b32 s76, s74
    s_mov_b32 s77, s75
    s_mov_b32 s78, 256
    s_mov_b32 s79, 0x00020000
    v_mov_b32 v250, 0
    s_mov_b32 s58, 0
L_WC1:
    buffer_load_dword v251, v250, s[76:79], 0 offen sc1
    s_add_u32 s58, s58, 1
    s_waitcnt vmcnt(0)
    v_readfirstlane_b32 s59, v251
    s_nop 0
    s_cmp_ge_u32 s59, 16
    s_cbranch_scc1 L_WC1_OK
    s_sleep 8
    s_cmp_lt_u32 s58, 400000
    s_cbranch_scc1 L_WC1
L_WC1_OK:
    s_branch L_ARRIVE
L_P2:
    s_setprio 0
    s_cmp_ge_u32 s2, 81
    s_cbranch_scc1 L_EXIT
    s_barrier
    s_cmp_lt_u32 s2, 72
    s_cbranch_scc1 L_FFN
    s_branch L_FIN
L_ROWP:
    v_and_b32 v2, 15, v0
    v_lshrrev_b32 v3, 4, v0
    v_lshlrev_b32 v4, 4, v0
    v_add_u32 v5, 1024, v4
    s_and_b32 s41, s2, 31
    s_lshr_b32 s42, s2, 5
    s_sub_u32 s42, s42, 4
    v_cmp_lt_u32 vcc, 7, v2
    s_cmp_eq_u32 s41, 0
    s_cbranch_scc1 L_P0
    v_and_b32 v8, 7, v2
    s_lshl_b32 s46, s42, 3
    v_add_u32 v8, s46, v8
    v_lshl_add_u32 v6, v8, 6, s41
    v_sub_u32 v8, 2048, v6
    v_cndmask_b32 v6, v6, v8, vcc
    v_xor_b32 v7, 8, v2
    s_branch L_ROWS
L_P0:
    v_bfe_u32 v8, v2, 1, 2
    s_lshl_b32 s46, s42, 2
    v_add_u32 v8, s46, v8
    v_sub_u32 v9, 32, v8
    v_sub_u32 v10, 31, v8
    v_cndmask_b32 v9, v9, v10, vcc
    v_mov_b32 v11, 0
    v_cndmask_b32 v11, v11, 32, vcc
    v_cmp_eq_u32 vcc, 32, v9
    s_nop 1
    v_cndmask_b32 v9, v9, 16, vcc
    v_xor_b32 v7, 1, v2
    v_cndmask_b32 v7, v7, v2, vcc
    v_and_b32 v10, 1, v2
    v_cmp_eq_u32 vcc, 1, v10
    s_nop 1
    v_cndmask_b32 v8, v8, v9, vcc
    v_lshl_add_u32 v6, v8, 6, v11
L_ROWS:
    s_lshl_b32 s44, s40, 1
    s_add_u32 s45, s44, 1
    v_and_b32 v9, 1, v3
    v_readlane_b32 s46, v6, s44
    v_readlane_b32 s47, v6, s45
    v_and_b32 v10, 31, v0
    v_mul_u32_u24 v12, 36, v10
    s_mov_b32 s24, s4
    s_mov_b32 s25, s5
    s_mov_b32 s26, 2359296
    s_mov_b32 s27, 0x00020000
    s_mov_b32 s28, s64
    s_mov_b32 s29, s65
    s_mov_b32 s30, 1152
    s_mov_b32 s31, 0x00020000
    s_mov_b32 s36, s14
    s_mov_b32 s37, s15
    s_mov_b32 s38, 9437184
    s_mov_b32 s39, 0x00020000
    s_mov_b32 s32, s72
    s_mov_b32 s33, s73
    s_mov_b32 s34, 2359296
    s_mov_b32 s35, 0x00020000
    s_mul_i32 s48, s40, 2304
    s_add_u32 s49, s48, 110720
    s_add_u32 s48, s48, 130176
    s_mul_i32 s82, s46, 1152
    s_mul_i32 s83, s47, 1152
    s_add_u32 m0, s48, 0
    s_nop 0
    buffer_load_dwordx4 v4, s[24:27], s82 offen lds
    s_mov_b64 exec, 0xff
    buffer_load_dwordx4 v4, s[24:27], s82 offen offset:1024 lds
    s_mov_b64 exec, -1
    s_add_u32 m0, s48, 1152
    s_nop 0
    buffer_load_dwordx4 v4, s[24:27], s83 offen lds
    s_mov_b64 exec, 0xff
    buffer_load_dwordx4 v4, s[24:27], s83 offen offset:1024 lds
    s_mov_b64 exec, -1
    s_mov_b32 m0, s49
    v_add_u32 v88, s49, v12
    buffer_load_dwordx4 v4, s[28:31], 0 offen lds
    s_mov_b64 exec, 0xff
    buffer_load_dwordx4 v4, s[28:31], 0 offen offset:1024 lds
    s_mov_b64 exec, -1
    v_add_u32 v89, s48, v4
    s_mul_i32 s45, s40, 9216
    s_mul_i32 s44, s41, 73728
    s_add_u32 s44, s44, s45
    s_lshl_b32 s56, s42, 11
    v_lshrrev_b32 v8, 2, v0
    v_lshlrev_b32 v8, 11, v8
    v_and_b32 v16, 3, v0
    v_lshl_add_u32 v8, v16, 6, v8
    s_lshl_b32 s48, s40, 8
    s_add_u32 s48, s48, 2375680
    s_mov_b32 s58, 0
    s_mov_b64 s[76:77], 0xffffff
L_UPOLL:
    s_mov_b64 exec, s[76:77]
    buffer_load_dword v16, v8, s[36:39], s48 offen sc1
    s_add_u32 s58, s58, 1
    s_waitcnt vmcnt(0)
    v_cmp_ne_u32 s[76:77], 0, v16
    s_mov_b64 exec, -1
    s_cmp_lt_u32 s58, 400000
    s_cbranch_scc0 L_UGO2
    s_cmp_eq_u64 s[76:77], 0
    s_cbranch_scc1 L_UGO2
    s_sleep 1
    s_branch L_UPOLL
L_UGO2:
    s_mov_b32 s84, 0
    v_mov_b32 v85, 156224
    s_add_u32 m0, s45, s56
    s_add_u32 s57, s44, s56
    buffer_load_dwordx4 v4, s[36:39], s57 offen sc1 lds
    s_add_u32 s56, s56, 1024
    s_cmp_eq_u32 s56, 9216
    s_cselect_b32 s56, 0, s56
    s_add_u32 m0, s45, s56
    s_add_u32 s57, s44, s56
    buffer_load_dwordx4 v4, s[36:39], s57 offen sc1 lds
    s_add_u32 s56, s56, 1024
    s_cmp_eq_u32 s56, 9216
    s_cselect_b32 s56, 0, s56
    s_add_u32 m0, s45, s56
    s_add_u32 s57, s44, s56
    buffer_load_dwordx4 v4, s[36:39], s57 offen sc1 lds
    s_add_u32 s56, s56, 1024
    s_cmp_eq_u32 s56, 9216
    s_cselect_b32 s56, 0, s56
    s_add_u32 m0, s45, s56
    s_add_u32 s57, s44, s56
    buffer_load_dwordx4 v4, s[36:39], s57 offen sc1 lds
    s_add_u32 s56, s56, 1024
    s_cmp_eq_u32 s56, 9216
    s_cselect_b32 s56, 0, s56
    s_add_u32 m0, s45, s56
    s_add_u32 s57, s44, s56
    buffer_load_dwordx4 v4, s[36:39], s57 offen sc1 lds
    s_add_u32 s56, s56, 1024
    s_cmp_eq_u32 s56, 9216
    s_cselect_b32 s56, 0, s56
    s_add_u32 m0, s45, s56
    s_add_u32 s57, s44, s56
    buffer_load_dwordx4 v4, s[36:39], s57 offen sc1 lds
    s_add_u32 s56, s56, 1024
    s_cmp_eq_u32 s56, 9216
    s_cselect_b32 s56, 0, s56
    s_add_u32 m0, s45, s56
    s_add_u32 s57, s44, s56
    buffer_load_dwordx4 v4, s[36:39], s57 offen sc1 lds
    s_add_u32 s56, s56, 1024
    s_cmp_eq_u32 s56, 9216
    s_cselect_b32 s56, 0, s56
    s_add_u32 m0, s45, s56
    s_add_u32 s57, s44, s56
    buffer_load_dwordx4 v4, s[36:39], s57 offen sc1 lds
    s_add_u32 s56, s56, 1024
    s_cmp_eq_u32 s56, 9216
    s_cselect_b32 s56, 0, s56
    s_add_u32 m0, s45, s56
    s_add_u32 s57, s44, s56
    buffer_load_dwordx4 v4, s[36:39], s57 offen sc1 lds
    s_add_u32 s56, s56, 1024
    s_cmp_eq_u32 s56, 9216
    s_cselect_b32 s56, 0, s56
    v_lshrrev_b32 v13, 1, v3
    v_lshlrev_b32 v13, 3, v13
    v_lshl_add_u32 v13, v9, 1, v13
    v_bfe_u32 v11, v0, 3, 1
    v_add_u32 v13, v13, v11
    v_mul_u32_u24 v13, 2304, v13
    v_lshl_add_u32 v13, v11, 6, v13
    v_and_b32 v11, 3, v0
    v_lshl_add_u32 v13, v11, 4, v13
    v_bfe_u32 v11, v0, 2, 1
    v_lshl_add_u32 v13, v11, 3, v13
    v_xor_b32 v11, s40, v9
    v_lshl_add_u32 v13, v11, 7, v13
    v_xor_b32 v81, 64, v13
    v_mul_u32_u24 v14, 2312, v2
    v_lshl_add_u32 v14, v3, 5, v14
    v_mul_u32_u24 v11, 2312, v7
    v_lshlrev_b32 v8, 5, v3
    v_sub_u32 v11, v11, v8
    s_add_u32 s48, s40, 0
    s_lshl_b32 s49, s48, 7
    s_sub_u32 s50, s49, 1148
    s_cmp_lt_u32 s48, 9
    s_cselect_b32 s49, s49, s50
    s_add_u32 s50, s49, 73728
    v_add_u32 v90, s50, v14
    s_sub_u32 s50, 76008, s49
    v_add_u32 v93, s50, v11
    s_add_u32 s48, s40, 6
    s_lshl_b32 s49, s48, 7
    s_sub_u32 s50, s49, 1148
    s_cmp_lt_u32 s48, 9
    s_cselect_b32 s49, s49, s50
    s_add_u32 s50, s49, 73728
    v_add_u32 v91, s50, v14
    s_sub_u32 s50, 76008, s49
    v_add_u32 v94, s50, v11
    s_add_u32 s48, s40, 12
    s_lshl_b32 s49, s48, 7
    s_sub_u32 s50, s49, 1148
    s_cmp_lt_u32 s48, 9
    s_cselect_b32 s49, s49, s50
    s_add_u32 s50, s49, 73728
    v_add_u32 v92, s50, v14
    s_sub_u32 s50, 76008, s49
    v_add_u32 v95, s50, v11
    v_lshrrev_b32 v8, 5, v0
    s_lshl_b32 s48, s40, 1
    v_add_u32 v8, s48, v8
    v_mul_u32_u24 v97, 2312, v8
    v_add_u32 v97, 73728, v97
    v_lshl_add_u32 v96, v12, 1, v97
    v_mul_u32_u24 v98, 1152, v8
    v_add_u32 v98, v98, v12
    v_add_u32 v98, 110720, v98
    v_cmp_eq_u32 s[60:61], 16, v10
    v_cmp_eq_u32 s[62:63], 0, v10
    v_add_u32 v15, 19456, v98
    v_mov_b32 v14, v88
    v_mov_b32 v11, v89
    v_cvt_f32_u32 v16, v6
    v_mul_f32 v16, 0x3a000000, v16
    v_lshrrev_b32 v17, 1, v3
    v_lshlrev_b32 v17, 3, v17
    v_lshl_add_u32 v17, v9, 1, v17
    v_cvt_f32_u32 v17, v17
    v_mul_f32 v17, v17, v16
    v_cmp_gt_u32 s[52:53], 8, v2
    v_fmamk_f32 v18, v16, 0x00000000, v17
    v_fmamk_f32 v19, v16, 0x3f800000, v17
    v_fmamk_f32 v20, v16, 0x40800000, v17
    v_fmamk_f32 v21, v16, 0x40a00000, v17
    v_fmamk_f32 v22, v16, 0x41800000, v17
    v_fmamk_f32 v23, v16, 0x41880000, v17
    v_fmamk_f32 v24, v16, 0x41a00000, v17
    v_fmamk_f32 v25, v16, 0x41a80000, v17
    v_cos_f32 v48, v18
    v_sin_f32 v18, v18
    v_cos_f32 v49, v19
    v_sin_f32 v19, v19
    v_cos_f32 v50, v20
    v_sin_f32 v20, v20
    v_cos_f32 v51, v21
    v_sin_f32 v21, v21
    v_cos_f32 v52, v22
    v_sin_f32 v22, v22
    v_cos_f32 v53, v23
    v_sin_f32 v23, v23
    v_cos_f32 v54, v24
    v_sin_f32 v24, v24
    v_cos_f32 v55, v25
    v_sin_f32 v25, v25
    v_cvt_pk_bf16_f32 v18, v48, v18
    v_cvt_pk_bf16_f32 v19, v49, v19
    v_cvt_pk_bf16_f32 v20, v50, v20
    v_cvt_pk_bf16_f32 v21, v51, v21
    v_cvt_pk_bf16_f32 v22, v52, v22
    v_cvt_pk_bf16_f32 v23, v53, v23
    v_cvt_pk_bf16_f32 v24, v54, v24
    v_cvt_pk_bf16_f32 v25, v55, v25
    v_cndmask_b32 v32, 0, v18, s[52:53]
    v_cndmask_b32 v40, v18, 0, s[52:53]
    v_cndmask_b32 v33, 0, v19, s[52:53]
    v_cndmask_b32 v41, v19, 0, s[52:53]
    v_cndmask_b32 v34, 0, v20, s[52:53]
    v_cndmask_b32 v42, v20, 0, s[52:53]
    v_cndmask_b32 v35, 0, v21, s[52:53]
    v_cndmask_b32 v43, v21, 0, s[52:53]
    v_cndmask_b32 v36, 0, v22, s[52:53]
    v_cndmask_b32 v44, v22, 0, s[52:53]
    v_cndmask_b32 v37, 0, v23, s[52:53]
    v_cndmask_b32 v45, v23, 0, s[52:53]
    v_cndmask_b32 v38, 0, v24, s[52:53]
    v_cndmask_b32 v46, v24, 0, s[52:53]
    v_cndmask_b32 v39, 0, v25, s[52:53]
    v_cndmask_b32 v47, v25, 0, s[52:53]
    s_waitcnt vmcnt(9)
    ds_read2_b32 v[140:141], v15 offset0:0 offset1:1
    ds_read2_b32 v[142:143], v15 offset0:2 offset1:3
    ds_read2_b32 v[144:145], v15 offset0:4 offset1:5
    ds_read2_b32 v[146:147], v15 offset0:6 offset1:7
    ds_read_b32 v148, v15 offset:32
    ds_read2_b32 v[152:153], v14 offset0:0 offset1:1
    ds_read2_b32 v[154:155], v14 offset0:2 offset1:3
    ds_read2_b32 v[156:157], v14 offset0:4 offset1:5
    ds_read2_b32 v[158:159], v14 offset0:6 offset1:7
    ds_read_b32 v160, v14 offset:32
    s_waitcnt lgkmcnt(0)
    v_lshlrev_b32 v100, 16, v140
    v_and_b32 v101, 0xffff0000, v140
    v_lshlrev_b32 v120, 16, v152
    v_and_b32 v121, 0xffff0000, v152
    v_lshlrev_b32 v102, 16, v141
    v_and_b32 v103, 0xffff0000, v141
    v_lshlrev_b32 v122, 16, v153
    v_and_b32 v123, 0xffff0000, v153
    v_lshlrev_b32 v104, 16, v142
    v_and_b32 v105, 0xffff0000, v142
    v_lshlrev_b32 v124, 16, v154
    v_and_b32 v125, 0xffff0000, v154
    v_lshlrev_b32 v106, 16, v143
    v_and_b32 v107, 0xffff0000, v143
    v_lshlrev_b32 v126, 16, v155
    v_and_b32 v127, 0xffff0000, v155
    v_lshlrev_b32 v108, 16, v144
    v_and_b32 v109, 0xffff0000, v144
    v_lshlrev_b32 v128, 16, v156
    v_and_b32 v129, 0xffff0000, v156
    v_lshlrev_b32 v110, 16, v145
    v_and_b32 v111, 0xffff0000, v145
    v_lshlrev_b32 v130, 16, v157
    v_and_b32 v131, 0xffff0000, v157
    v_lshlrev_b32 v112, 16, v146
    v_and_b32 v113, 0xffff0000, v146
    v_lshlrev_b32 v132, 16, v158
    v_and_b32 v133, 0xffff0000, v158
    v_lshlrev_b32 v114, 16, v147
    v_and_b32 v115, 0xffff0000, v147
    v_lshlrev_b32 v134, 16, v159
    v_and_b32 v135, 0xffff0000, v159
    v_lshlrev_b32 v116, 16, v148
    v_and_b32 v117, 0xffff0000, v148
    v_lshlrev_b32 v136, 16, v160
    v_and_b32 v137, 0xffff0000, v160
    v_pk_add_f32 v[86:87], v[120:121], v[122:123]
    v_pk_add_f32 v[86:87], v[86:87], v[124:125]
    v_pk_add_f32 v[86:87], v[86:87], v[126:127]
    v_pk_add_f32 v[86:87], v[86:87], v[128:129]
    v_pk_add_f32 v[86:87], v[86:87], v[130:131]
    v_pk_add_f32 v[86:87], v[86:87], v[132:133]
    v_pk_add_f32 v[86:87], v[86:87], v[134:135]
    v_pk_add_f32 v[86:87], v[86:87], v[136:137]
    v_add_f32 v99, v86, v87
    s_nop 1
    v_add_f32_dpp v99, v99, v99 row_shr:1 row_mask:0xf bank_mask:0xf
    s_nop 1
    v_add_f32_dpp v99, v99, v99 row_shr:2 row_mask:0xf bank_mask:0xf
    s_nop 1
    v_add_f32_dpp v99, v99, v99 row_shr:4 row_mask:0xf bank_mask:0xf
    s_nop 1
    v_add_f32_dpp v99, v99, v99 row_shr:8 row_mask:0xf bank_mask:0xf
    s_nop 1
    v_add_f32_dpp v99, v99, v99 row_bcast:15 row_mask:0xa bank_mask:0xf
    v_lshrrev_b32 v213, 5, v0
    s_lshl_b32 s58, s40, 1
    v_add_u32 v213, s58, v213
    s_sub_u32 s85, s2, 128
    s_lshl_b32 s58, s85, 4
    s_sub_u32 s58, 2047, s58
    v_sub_u32 v212, s58, v213
    v_lshlrev_b32 v213, 2, v213
    v_add_u32 v213, 156160, v213
    v_lshlrev_b32 v214, 2, v2
    v_add_u32 v214, 156160, v214
L_UWAIT:
    v_mov_b32 v86, 0
    ds_write_b32 v85, v86
    s_waitcnt vmcnt(0) lgkmcnt(0)
    s_barrier
    s_cmp_ge_u32 s40, 6
    s_cbranch_scc1 L_SKIPMM
    ds_read_b64_tr_b16 v[164:165], v13 offset:0
    ds_read_b64_tr_b16 v[166:167], v13 offset:9216
    ds_read_b64_tr_b16 v[168:169], v13 offset:768
    ds_read_b64_tr_b16 v[170:171], v13 offset:9984
    ds_read_b64_tr_b16 v[172:173], v13 offset:1536
    ds_read_b64_tr_b16 v[174:175], v13 offset:10752
    ds_read_b64_tr_b16 v[176:177], v13 offset:36864
    ds_read_b64_tr_b16 v[178:179], v13 offset:46080
    ds_read_b64_tr_b16 v[180:181], v13 offset:37632
    ds_read_b64_tr_b16 v[182:183], v13 offset:46848
    ds_read_b64_tr_b16 v[184:185], v13 offset:38400
    ds_read_b64_tr_b16 v[186:187], v13 offset:47616
    ds_read_b64_tr_b16 v[188:189], v81 offset:0
    ds_read_b64_tr_b16 v[190:191], v81 offset:9216
    s_waitcnt lgkmcnt(12)
    v_mfma_f32_16x16x32_bf16 v[48:51], v[164:167], v[32:35], 0
    ds_read_b64_tr_b16 v[192:193], v81 offset:768
    ds_read_b64_tr_b16 v[194:195], v81 offset:9984
    s_waitcnt lgkmcnt(12)
    v_mfma_f32_16x16x32_bf16 v[52:55], v[168:171], v[32:35], 0
    ds_read_b64_tr_b16 v[196:197], v81 offset:1536
    ds_read_b64_tr_b16 v[198:199], v81 offset:10752
    s_waitcnt lgkmcnt(12)
    v_mfma_f32_16x16x32_bf16 v[56:59], v[172:175], v[32:35], 0
    ds_read_b64_tr_b16 v[200:201], v81 offset:36864
    ds_read_b64_tr_b16 v[202:203], v81 offset:46080
    s_waitcnt lgkmcnt(12)
    v_mfma_f32_16x16x32_bf16 v[48:51], v[176:179], v[36:39], v[48:51]
    ds_read_b64_tr_b16 v[204:205], v81 offset:37632
    ds_read_b64_tr_b16 v[206:207], v81 offset:46848
    s_waitcnt lgkmcnt(12)
    v_mfma_f32_16x16x32_bf16 v[52:55], v[180:183], v[36:39], v[52:55]
    ds_read_b64_tr_b16 v[208:209], v81 offset:38400
    ds_read_b64_tr_b16 v[210:211], v81 offset:47616
    s_waitcnt lgkmcnt(12)
    v_mfma_f32_16x16x32_bf16 v[56:59], v[184:187], v[36:39], v[56:59]
    s_waitcnt lgkmcnt(10)
    v_mfma_f32_16x16x32_bf16 v[48:51], v[188:191], v[40:43], v[48:51]
    s_waitcnt lgkmcnt(8)
    v_mfma_f32_16x16x32_bf16 v[52:55], v[192:195], v[40:43], v[52:55]
    s_waitcnt lgkmcnt(6)
    v_mfma_f32_16x16x32_bf16 v[56:59], v[196:199], v[40:43], v[56:59]
    s_waitcnt lgkmcnt(4)
    v_mfma_f32_16x16x32_bf16 v[48:51], v[200:203], v[44:47], v[48:51]
    s_waitcnt lgkmcnt(2)
    v_mfma_f32_16x16x32_bf16 v[52:55], v[204:207], v[44:47], v[52:55]
    s_waitcnt lgkmcnt(0)
    v_mfma_f32_16x16x32_bf16 v[56:59], v[208:211], v[44:47], v[56:59]
    s_nop 3
    ds_write2_b32 v90, v48, v49 offset0:0 offset1:2
    ds_write2_b32 v90, v50, v51 offset0:4 offset1:6
    ds_write2_b32 v93, v51, v50 offset0:0 offset1:2
    ds_write2_b32 v93, v49, v48 offset0:4 offset1:6
    ds_write2_b32 v91, v52, v53 offset0:0 offset1:2
    ds_write2_b32 v91, v54, v55 offset0:4 offset1:6
    ds_write2_b32 v94, v55, v54 offset0:0 offset1:2
    ds_write2_b32 v94, v53, v52 offset0:4 offset1:6
    ds_write2_b32 v92, v56, v57 offset0:0 offset1:2
    ds_write2_b32 v92, v58, v59 offset0:4 offset1:6
    ds_write2_b32 v95, v59, v58 offset0:0 offset1:2
    ds_write2_b32 v95, v57, v56 offset0:4 offset1:6
    s_waitcnt lgkmcnt(0)
L_SKIPMM:
    s_barrier
    ds_read_b32 v86, v85
    ds_read_b32 v88, v97
    ds_read_b64 v[60:61], v96 offset:0
    ds_read_b64 v[62:63], v96 offset:8
    ds_read_b64 v[64:65], v96 offset:16
    ds_read_b64 v[66:67], v96 offset:24
    ds_read_b64 v[68:69], v96 offset:32
    ds_read_b64 v[70:71], v96 offset:40
    ds_read_b64 v[72:73], v96 offset:48
    ds_read_b64 v[74:75], v96 offset:56
    ds_read_b64 v[76:77], v96 offset:64
    s_waitcnt lgkmcnt(8)
    v_cndmask_b32 v60, v60, v88, s[60:61]
    v_cndmask_b32 v60, v60, 0, s[62:63]
    s_mov_b32 s56, s85
    s_mul_i32 s57, s56, 1152
    s_add_u32 s57, s57, 2553856
    s_lshl_b32 s59, s56, 7
    s_add_u32 s59, s59, 2359296
    v_pk_add_f32 v[60:61], v[60:61], v[100:101]
    s_waitcnt lgkmcnt(7)
    v_pk_add_f32 v[62:63], v[62:63], v[102:103]
    s_waitcnt lgkmcnt(6)
    v_pk_add_f32 v[64:65], v[64:65], v[104:105]
    s_waitcnt lgkmcnt(5)
    v_pk_add_f32 v[66:67], v[66:67], v[106:107]
    s_waitcnt lgkmcnt(4)
    v_pk_add_f32 v[68:69], v[68:69], v[108:109]
    s_waitcnt lgkmcnt(3)
    v_pk_add_f32 v[70:71], v[70:71], v[110:111]
    s_waitcnt lgkmcnt(2)
    v_pk_add_f32 v[72:73], v[72:73], v[112:113]
    s_waitcnt lgkmcnt(1)
    v_pk_add_f32 v[74:75], v[74:75], v[114:115]
    s_waitcnt lgkmcnt(0)
    v_pk_add_f32 v[76:77], v[76:77], v[116:117]
    v_pk_add_f32 v[26:27], v[60:61], v[62:63]
    v_pk_mul_f32 v[28:29], v[60:61], v[60:61]
    v_pk_mul_f32 v[30:31], v[60:61], v[120:121]
    v_pk_fma_f32 v[28:29], v[62:63], v[62:63], v[28:29]
    v_pk_fma_f32 v[30:31], v[62:63], v[122:123], v[30:31]
    v_pk_add_f32 v[26:27], v[26:27], v[64:65]
    v_pk_fma_f32 v[28:29], v[64:65], v[64:65], v[28:29]
    v_pk_fma_f32 v[30:31], v[64:65], v[124:125], v[30:31]
    v_pk_add_f32 v[26:27], v[26:27], v[66:67]
    v_pk_fma_f32 v[28:29], v[66:67], v[66:67], v[28:29]
    v_pk_fma_f32 v[30:31], v[66:67], v[126:127], v[30:31]
    v_pk_add_f32 v[26:27], v[26:27], v[68:69]
    v_pk_fma_f32 v[28:29], v[68:69], v[68:69], v[28:29]
    v_pk_fma_f32 v[30:31], v[68:69], v[128:129], v[30:31]
    v_pk_add_f32 v[26:27], v[26:27], v[70:71]
    v_pk_fma_f32 v[28:29], v[70:71], v[70:71], v[28:29]
    v_pk_fma_f32 v[30:31], v[70:71], v[130:131], v[30:31]
    v_pk_add_f32 v[26:27], v[26:27], v[72:73]
    v_pk_fma_f32 v[28:29], v[72:73], v[72:73], v[28:29]
    v_pk_fma_f32 v[30:31], v[72:73], v[132:133], v[30:31]
    v_pk_add_f32 v[26:27], v[26:27], v[74:75]
    v_pk_fma_f32 v[28:29], v[74:75], v[74:75], v[28:29]
    v_pk_fma_f32 v[30:31], v[74:75], v[134:135], v[30:31]
    v_pk_add_f32 v[26:27], v[26:27], v[76:77]
    v_pk_fma_f32 v[28:29], v[76:77], v[76:77], v[28:29]
    v_pk_fma_f32 v[30:31], v[76:77], v[136:137], v[30:31]
    v_add_f32 v82, v26, v27
    v_add_f32 v83, v28, v29
    v_add_f32 v84, v30, v31
    v_add_f32_dpp v82, v82, v82 row_shr:1 row_mask:0xf bank_mask:0xf
    v_add_f32_dpp v83, v83, v83 row_shr:1 row_mask:0xf bank_mask:0xf
    v_add_f32_dpp v84, v84, v84 row_shr:1 row_mask:0xf bank_mask:0xf
    v_add_f32_dpp v82, v82, v82 row_shr:2 row_mask:0xf bank_mask:0xf
    v_add_f32_dpp v83, v83, v83 row_shr:2 row_mask:0xf bank_mask:0xf
    v_add_f32_dpp v84, v84, v84 row_shr:2 row_mask:0xf bank_mask:0xf
    v_add_f32_dpp v82, v82, v82 row_shr:4 row_mask:0xf bank_mask:0xf
    v_add_f32_dpp v83, v83, v83 row_shr:4 row_mask:0xf bank_mask:0xf
    v_add_f32_dpp v84, v84, v84 row_shr:4 row_mask:0xf bank_mask:0xf
    v_add_f32_dpp v82, v82, v82 row_shr:8 row_mask:0xf bank_mask:0xf
    v_add_f32_dpp v83, v83, v83 row_shr:8 row_mask:0xf bank_mask:0xf
    v_add_f32_dpp v84, v84, v84 row_shr:8 row_mask:0xf bank_mask:0xf
    v_add_f32_dpp v82, v82, v82 row_bcast:15 row_mask:0xa bank_mask:0xf
    v_add_f32_dpp v83, v83, v83 row_bcast:15 row_mask:0xa bank_mask:0xf
    v_add_f32_dpp v84, v84, v84 row_bcast:15 row_mask:0xa bank_mask:0xf
    v_mul_f32 v82, 0x3ae38e39, v82
    v_mul_f32 v83, 0x3ae38e39, v83
    v_fma_f32 v83, -v82, v82, v83
    v_max_f32 v83, 0, v83
    v_cvt_pk_bf16_f32 v83, v83, v83
    v_and_b32 v83, 0xffff0000, v83
    v_cvt_pk_bf16_f32 v82, v82, v82
    v_and_b32 v82, 0xffff0000, v82
    v_add_f32 v83, 0x3727c5ac, v83
    v_cvt_pk_bf16_f32 v83, v83, v83
    v_and_b32 v83, 0xffff0000, v83
    v_sqrt_f32 v83, v83
    v_fma_f32 v84, -v82, v99, v84
    v_cvt_pk_bf16_f32 v83, v83, v83
    v_and_b32 v83, 0xffff0000, v83
    v_rcp_f32 v83, v83
    s_nop 0
    v_mul_f32 v84, v84, v83
    v_ashrrev_i32 v85, 31, v84
    v_or_b32 v85, 0x80000000, v85
    v_xor_b32 v85, v85, v84
    v_and_b32 v85, 0xfffff800, v85
    v_max_u32 v85, 0x800, v85
    v_or_b32 v85, v85, v212
    s_mov_b32 exec_lo, 0x80000000
    s_mov_b32 exec_hi, 0x80000000
    ds_write_b32 v213, v85
    s_mov_b64 exec, -1
    v_mul_f32 v82, v82, v83
    v_readlane_b32 s52, v85, 31
    v_readlane_b32 s53, v85, 63
    s_waitcnt lgkmcnt(0)
    s_setprio 3
    s_barrier
    ds_read_b32 v85, v214
    v_readlane_b32 s48, v83, 31
    v_readlane_b32 s49, v83, 63
    v_readlane_b32 s50, v82, 31
    v_readlane_b32 s51, v82, 63
    v_readlane_b32 s54, v84, 31
    v_readlane_b32 s55, v84, 63
    s_cmp_gt_u32 s52, s53
    s_cselect_b32 s52, s52, s53
    s_cselect_b32 s54, s54, s55
    s_cselect_b32 s46, s46, s47
    s_cselect_b32 s55, 0, 1
    s_not_b32 s53, s52
    v_mov_b32 v87, s53
    v_mov_b32 v86, 0
    s_waitcnt lgkmcnt(0)
    v_max_u32_dpp v85, v85, v85 row_shr:1 row_mask:0xf bank_mask:0xf
    s_nop 1
    v_max_u32_dpp v85, v85, v85 row_shr:2 row_mask:0xf bank_mask:0xf
    s_nop 1
    v_max_u32_dpp v85, v85, v85 row_shr:4 row_mask:0xf bank_mask:0xf
    s_nop 1
    v_max_u32_dpp v85, v85, v85 row_shr:8 row_mask:0xf bank_mask:0xf
    s_nop 0
    v_readlane_b32 s58, v85, 15
    s_nop 0
    s_cmp_eq_u32 s58, s52
    s_cbranch_scc1 L_WIN1
    s_setprio 0
    s_branch L_NW1
L_WIN1:
    s_mov_b64 exec, 1
    buffer_store_dword v87, v86, s[36:39], s59 offen sc1
    s_mov_b64 exec, -1
L_NW1:
    v_mov_b32 v80, s48
    v_mov_b32 v78, s50
    s_mov_b32 exec_lo, 0
    v_mov_b32 v80, s49
    v_mov_b32 v78, s51
    s_mov_b32 exec_lo, -1
    v_cvt_pk_bf16_f32 v16, v60, v61
    v_cvt_pk_bf16_f32 v17, v62, v63
    v_cvt_pk_bf16_f32 v18, v64, v65
    v_cvt_pk_bf16_f32 v19, v66, v67
    v_cvt_pk_bf16_f32 v20, v68, v69
    v_cvt_pk_bf16_f32 v21, v70, v71
    v_cvt_pk_bf16_f32 v22, v72, v73
    v_cvt_pk_bf16_f32 v23, v74, v75
    v_cvt_pk_bf16_f32 v24, v76, v77
    v_lshlrev_b32 v60, 16, v16
    v_and_b32 v61, 0xffff0000, v16
    v_lshlrev_b32 v62, 16, v17
    v_and_b32 v63, 0xffff0000, v17
    v_lshlrev_b32 v64, 16, v18
    v_and_b32 v65, 0xffff0000, v18
    v_lshlrev_b32 v66, 16, v19
    v_and_b32 v67, 0xffff0000, v19
    v_lshlrev_b32 v68, 16, v20
    v_and_b32 v69, 0xffff0000, v20
    v_lshlrev_b32 v70, 16, v21
    v_and_b32 v71, 0xffff0000, v21
    v_lshlrev_b32 v72, 16, v22
    v_and_b32 v73, 0xffff0000, v22
    v_lshlrev_b32 v74, 16, v23
    v_and_b32 v75, 0xffff0000, v23
    v_lshlrev_b32 v76, 16, v24
    v_and_b32 v77, 0xffff0000, v24
    v_pk_fma_f32 v[100:101], v[60:61], v[80:81], v[78:79] op_sel_hi:[1,0,0] neg_lo:[0,0,1] neg_hi:[0,0,1]
    v_pk_fma_f32 v[102:103], v[62:63], v[80:81], v[78:79] op_sel_hi:[1,0,0] neg_lo:[0,0,1] neg_hi:[0,0,1]
    v_pk_fma_f32 v[104:105], v[64:65], v[80:81], v[78:79] op_sel_hi:[1,0,0] neg_lo:[0,0,1] neg_hi:[0,0,1]
    v_pk_fma_f32 v[106:107], v[66:67], v[80:81], v[78:79] op_sel_hi:[1,0,0] neg_lo:[0,0,1] neg_hi:[0,0,1]
    v_pk_fma_f32 v[108:109], v[68:69], v[80:81], v[78:79] op_sel_hi:[1,0,0] neg_lo:[0,0,1] neg_hi:[0,0,1]
    v_pk_fma_f32 v[110:111], v[70:71], v[80:81], v[78:79] op_sel_hi:[1,0,0] neg_lo:[0,0,1] neg_hi:[0,0,1]
    v_pk_fma_f32 v[112:113], v[72:73], v[80:81], v[78:79] op_sel_hi:[1,0,0] neg_lo:[0,0,1] neg_hi:[0,0,1]
    v_pk_fma_f32 v[114:115], v[74:75], v[80:81], v[78:79] op_sel_hi:[1,0,0] neg_lo:[0,0,1] neg_hi:[0,0,1]
    v_pk_fma_f32 v[116:117], v[76:77], v[80:81], v[78:79] op_sel_hi:[1,0,0] neg_lo:[0,0,1] neg_hi:[0,0,1]
    v_cvt_pk_bf16_f32 v140, v100, v101
    v_cvt_pk_bf16_f32 v141, v102, v103
    v_cvt_pk_bf16_f32 v142, v104, v105
    v_cvt_pk_bf16_f32 v143, v106, v107
    v_cvt_pk_bf16_f32 v144, v108, v109
    v_cvt_pk_bf16_f32 v145, v110, v111
    v_cvt_pk_bf16_f32 v146, v112, v113
    v_cvt_pk_bf16_f32 v147, v114, v115
    v_cvt_pk_bf16_f32 v148, v116, v117
    s_cmp_lg_u32 s58, s52
    s_cbranch_scc1 L_NOTWIN
    ds_write2_b32 v98, v140, v141 offset0:0 offset1:1
    ds_write2_b32 v98, v142, v143 offset0:2 offset1:3
    ds_write2_b32 v98, v144, v145 offset0:4 offset1:5
    ds_write2_b32 v98, v146, v147 offset0:6 offset1:7
    ds_write_b32 v98, v148 offset:32
    s_lshl_b32 s60, s40, 1
    s_add_u32 s60, s60, s55
    s_mul_i32 s60, s60, 1152
    s_add_u32 s60, s60, 110720
    v_add_u32 v88, s60, v4
    ds_read_b128 v[32:35], v88
    ds_read_b128 v[36:39], v88 offset:1024
    s_waitcnt lgkmcnt(0)
    buffer_store_dwordx4 v[32:35], v4, s[36:39], s57 offen sc1
    s_mov_b64 exec, 0xff
    buffer_store_dwordx4 v[36:39], v5, s[36:39], s57 offen sc1
    s_mov_b64 exec, -1
    s_setprio 0
L_NOTWIN:
    v_lshlrev_b32 v100, 16, v140
    v_and_b32 v101, 0xffff0000, v140
    v_lshlrev_b32 v102, 16, v141
    v_and_b32 v103, 0xffff0000, v141
    v_lshlrev_b32 v104, 16, v142
    v_and_b32 v105, 0xffff0000, v142
    v_lshlrev_b32 v106, 16, v143
    v_and_b32 v107, 0xffff0000, v143
    v_lshlrev_b32 v108, 16, v144
    v_and_b32 v109, 0xffff0000, v144
    v_lshlrev_b32 v110, 16, v145
    v_and_b32 v111, 0xffff0000, v145
    v_lshlrev_b32 v112, 16, v146
    v_and_b32 v113, 0xffff0000, v146
    v_lshlrev_b32 v114, 16, v147
    v_and_b32 v115, 0xffff0000, v147
    v_lshlrev_b32 v116, 16, v148
    v_and_b32 v117, 0xffff0000, v148
    v_pk_add_f32 v[100:101], v[100:101], v[60:61]
    v_pk_add_f32 v[102:103], v[102:103], v[62:63]
    v_pk_add_f32 v[104:105], v[104:105], v[64:65]
    v_pk_add_f32 v[106:107], v[106:107], v[66:67]
    v_pk_add_f32 v[108:109], v[108:109], v[68:69]
    v_pk_add_f32 v[110:111], v[110:111], v[70:71]
    v_pk_add_f32 v[112:113], v[112:113], v[72:73]
    v_pk_add_f32 v[114:115], v[114:115], v[74:75]
    v_pk_add_f32 v[116:117], v[116:117], v[76:77]
    v_cvt_pk_bf16_f32 v152, v100, v101
    v_cvt_pk_bf16_f32 v153, v102, v103
    v_cvt_pk_bf16_f32 v154, v104, v105
    v_cvt_pk_bf16_f32 v155, v106, v107
    v_cvt_pk_bf16_f32 v156, v108, v109
    v_cvt_pk_bf16_f32 v157, v110, v111
    v_cvt_pk_bf16_f32 v158, v112, v113
    v_cvt_pk_bf16_f32 v159, v114, v115
    v_cvt_pk_bf16_f32 v160, v116, v117
    ds_write2_b32 v15, v152, v153 offset0:0 offset1:1
    ds_write2_b32 v15, v154, v155 offset0:2 offset1:3
    ds_write2_b32 v15, v156, v157 offset0:4 offset1:5
    ds_write2_b32 v15, v158, v159 offset0:6 offset1:7
    ds_write_b32 v15, v160 offset:32
    s_waitcnt lgkmcnt(0)
    ds_read_b128 v[40:43], v11
    ds_read_b128 v[44:47], v11 offset:1024
    ds_read_b128 v[48:51], v11 offset:1152
    ds_read_b128 v[52:55], v11 offset:2176
    s_cmp_lg_u32 s58, s52
    s_cbranch_scc1 L_PLAIN
    s_waitcnt lgkmcnt(0)
    buffer_store_dwordx4 v[40:43], v4, s[32:35], s82 offen sc1
    buffer_store_dwordx4 v[48:51], v4, s[32:35], s83 offen sc1
    s_mov_b64 exec, 0xff
    buffer_store_dwordx4 v[44:47], v5, s[32:35], s82 offen sc1
    buffer_store_dwordx4 v[52:55], v5, s[32:35], s83 offen sc1
    s_mov_b64 exec, -1
    s_mul_i32 s57, s56, 1280
    s_add_u32 s57, s57, 2752512
    v_mov_b32 v88, s54
    v_mov_b32 v89, s46
    s_cmp_eq_u32 s55, 0
    s_cselect_b32 exec_lo, -1, 0
    s_cselect_b32 exec_hi, 0, -1
    buffer_store_dwordx4 v[16:19], v12, s[36:39], s57 offen sc1
    buffer_store_dwordx4 v[20:23], v12, s[36:39], s57 offen offset:16 sc1
    buffer_store_dword v24, v12, s[36:39], s57 offen offset:32 sc1
    s_mov_b64 exec, 1
    buffer_store_dwordx2 v[88:89], v86, s[36:39], s57 offen offset:1152 sc1
    s_waitcnt vmcnt(0)
    buffer_store_dword v86, v86, s[36:39], s59 offen offset:64 sc1
    s_mov_b64 exec, -1
    s_branch L_EXIT
L_PLAIN:
    s_waitcnt lgkmcnt(0)
    buffer_store_dwordx4 v[40:43], v4, s[32:35], s82 offen sc1
    buffer_store_dwordx4 v[48:51], v4, s[32:35], s83 offen sc1
    s_mov_b64 exec, 0xff
    buffer_store_dwordx4 v[44:47], v5, s[32:35], s82 offen sc1
    buffer_store_dwordx4 v[52:55], v5, s[32:35], s83 offen sc1
    s_mov_b64 exec, -1
    s_branch L_EXIT
L_FFN:
    v_and_b32 v2, 15, v0
    v_lshrrev_b32 v3, 4, v0
    v_lshlrev_b32 v4, 4, v0
    v_add_u32 v5, 1024, v4
    s_and_b32 s3, s2, 7
    s_mul_i32 s3, s3, 9
    s_lshr_b32 s41, s2, 3
    s_add_u32 s3, s3, s41
    s_mov_b32 s16, s66
    s_mov_b32 s17, s67
    s_mov_b32 s18, 5308416
    s_mov_b32 s19, 0x00020000
    s_mov_b32 s20, s68
    s_mov_b32 s21, s69
    s_mov_b32 s22, 5308416
    s_mov_b32 s23, 0x00020000
    s_mov_b32 s24, s70
    s_mov_b32 s25, s71
    s_mov_b32 s26, 5308416
    s_mov_b32 s27, 0x00020000
    s_mov_b32 s36, s14
    s_mov_b32 s37, s15
    s_mov_b32 s38, 9437184
    s_mov_b32 s39, 0x00020000
    v_lshrrev_b32 v8, 3, v0
    v_and_b32 v9, 7, v0
    v_and_b32 v10, 2, v8
    v_xor_b32 v9, v9, v10
    s_and_b32 s58, s40, 1
    s_lshl_b32 s58, s58, 2
    v_xor_b32 v9, s58, v9
    v_lshlrev_b32 v9, 4, v9
    v_mul_u32_u24 v15, 9216, v8
    v_add_u32 v15, v15, v9
    v_xor_b32 v14, 64, v15
    v_mul_u32_u24 v11, 1152, v8
    v_add_u32 v11, v11, v9
    s_mul_i32 s59, s40, 663552
    s_lshl_b32 s58, s3, 7
    s_add_u32 s59, s59, s58
    s_mul_i32 s55, s40, 9216
    s_add_u32 m0, s55, 0
    s_nop 0
    buffer_load_dwordx4 v15, s[16:19], s59 offen lds
    s_add_u32 m0, s55, 73728
    s_nop 0
    buffer_load_dwordx4 v15, s[20:23], s59 offen lds
    s_add_u32 s59, s59, 73728
    s_add_u32 m0, s55, 1024
    s_nop 0
    buffer_load_dwordx4 v14, s[16:19], s59 offen lds
    s_add_u32 m0, s55, 74752
    s_nop 0
    buffer_load_dwordx4 v14, s[20:23], s59 offen lds
    s_add_u32 s59, s59, 73728
    s_add_u32 m0, s55, 2048
    s_nop 0
    buffer_load_dwordx4 v15, s[16:19], s59 offen lds
    s_add_u32 m0, s55, 75776
    s_nop 0
    buffer_load_dwordx4 v15, s[20:23], s59 offen lds
    s_add_u32 s59, s59, 73728
    s_add_u32 m0, s55, 3072
    s_nop 0
    buffer_load_dwordx4 v14, s[16:19], s59 offen lds
    s_add_u32 m0, s55, 76800
    s_nop 0
    buffer_load_dwordx4 v14, s[20:23], s59 offen lds
    s_add_u32 s59, s59, 73728
    s_add_u32 m0, s55, 4096
    s_nop 0
    buffer_load_dwordx4 v15, s[16:19], s59 offen lds
    s_add_u32 m0, s55, 77824
    s_nop 0
    buffer_load_dwordx4 v15, s[20:23], s59 offen lds
    s_add_u32 s59, s59, 73728
    s_add_u32 m0, s55, 5120
    s_nop 0
    buffer_load_dwordx4 v14, s[16:19], s59 offen lds
    s_add_u32 m0, s55, 78848
    s_nop 0
    buffer_load_dwordx4 v14, s[20:23], s59 offen lds
    s_add_u32 s59, s59, 73728
    s_add_u32 m0, s55, 6144
    s_nop 0
    buffer_load_dwordx4 v15, s[16:19], s59 offen lds
    s_add_u32 m0, s55, 79872
    s_nop 0
    buffer_load_dwordx4 v15, s[20:23], s59 offen lds
    s_add_u32 s59, s59, 73728
    s_add_u32 m0, s55, 7168
    s_nop 0
    buffer_load_dwordx4 v14, s[16:19], s59 offen lds
    s_add_u32 m0, s55, 80896
    s_nop 0
    buffer_load_dwordx4 v14, s[20:23], s59 offen lds
    s_add_u32 s59, s59, 73728
    s_add_u32 m0, s55, 8192
    s_nop 0
    buffer_load_dwordx4 v15, s[16:19], s59 offen lds
    s_add_u32 m0, s55, 81920
    s_nop 0
    buffer_load_dwordx4 v15, s[20:23], s59 offen lds
    s_mul_i32 s59, s3, 73728
    s_add_u32 s59, s59, s55
    buffer_load_dwordx4 v[200:203], v11, s[24:27], s59 offen offset:0
    buffer_load_dwordx4 v[204:207], v11, s[24:27], s59 offen offset:128
    buffer_load_dwordx4 v[208:211], v11, s[24:27], s59 offen offset:256
    buffer_load_dwordx4 v[212:215], v11, s[24:27], s59 offen offset:384
    buffer_load_dwordx4 v[216:219], v11, s[24:27], s59 offen offset:512
    buffer_load_dwordx4 v[220:223], v11, s[24:27], s59 offen offset:640
    buffer_load_dwordx4 v[224:227], v11, s[24:27], s59 offen offset:768
    buffer_load_dwordx4 v[228:231], v11, s[24:27], s59 offen offset:896
    buffer_load_dwordx4 v[232:235], v11, s[24:27], s59 offen offset:1024
    v_add_u32 v11, s55, v4
    v_bfe_u32 v13, v0, 2, 2
    v_lshrrev_b32 v10, 1, v13
    v_and_b32 v6, 1, v3
    v_lshl_add_u32 v10, v6, 1, v10
    s_and_b32 s57, s40, 3
    s_lshr_b32 s56, s40, 2
    v_xor_b32 v10, s57, v10
    v_lshlrev_b32 v10, 5, v10
    v_and_b32 v6, 3, v0
    v_lshl_add_u32 v10, v6, 3, v10
    v_lshl_add_u32 v10, v13, 7, v10
    v_mul_u32_u24 v14, 9216, v3
    v_add_u32 v14, v14, v10
    s_lshl_b32 s58, s56, 10
    v_add_u32 v14, s58, v14
    v_lshl_add_u32 v13, v3, 10, v10
    s_mul_i32 s54, s56, 36864
    v_add_u32 v13, s54, v13
    v_add_u32 v12, 73728, v13
    s_waitcnt vmcnt(9)
    s_mov_b32 s76, s74
    s_mov_b32 s77, s75
    s_mov_b32 s78, 256
    s_mov_b32 s79, 0x00020000
    v_mov_b32 v250, 0
    s_cmp_eq_u32 s40, 7
    s_cselect_b32 s78, 256, 0
    buffer_load_dword v251, v250, s[76:79], 0 offen sc1
    s_barrier
    ds_read_b64_tr_b16 v[64:65], v13 offset:0
    ds_read_b64_tr_b16 v[66:67], v13 offset:512
    ds_read_b64_tr_b16 v[68:69], v12 offset:0
    ds_read_b64_tr_b16 v[70:71], v12 offset:512
    ds_read_b64_tr_b16 v[72:73], v13 offset:4096
    ds_read_b64_tr_b16 v[74:75], v13 offset:4608
    ds_read_b64_tr_b16 v[76:77], v12 offset:4096
    ds_read_b64_tr_b16 v[78:79], v12 offset:4608
    ds_read_b64_tr_b16 v[80:81], v13 offset:8192
    ds_read_b64_tr_b16 v[82:83], v13 offset:8704
    ds_read_b64_tr_b16 v[84:85], v12 offset:8192
    ds_read_b64_tr_b16 v[86:87], v12 offset:8704
    s_waitcnt lgkmcnt(0)
    ds_read_b64_tr_b16 v[88:89], v13 offset:12288
    ds_read_b64_tr_b16 v[90:91], v13 offset:12800
    ds_read_b64_tr_b16 v[92:93], v12 offset:12288
    ds_read_b64_tr_b16 v[94:95], v12 offset:12800
    ds_read_b64_tr_b16 v[96:97], v13 offset:16384
    ds_read_b64_tr_b16 v[98:99], v13 offset:16896
    ds_read_b64_tr_b16 v[100:101], v12 offset:16384
    ds_read_b64_tr_b16 v[102:103], v12 offset:16896
    ds_read_b64_tr_b16 v[104:105], v13 offset:20480
    ds_read_b64_tr_b16 v[106:107], v13 offset:20992
    ds_read_b64_tr_b16 v[108:109], v12 offset:20480
    ds_read_b64_tr_b16 v[110:111], v12 offset:20992
    s_waitcnt lgkmcnt(0)
    ds_read_b64_tr_b16 v[112:113], v13 offset:24576
    ds_read_b64_tr_b16 v[114:115], v13 offset:25088
    ds_read_b64_tr_b16 v[116:117], v12 offset:24576
    ds_read_b64_tr_b16 v[118:119], v12 offset:25088
    ds_read_b64_tr_b16 v[120:121], v13 offset:28672
    ds_read_b64_tr_b16 v[122:123], v13 offset:29184
    ds_read_b64_tr_b16 v[124:125], v12 offset:28672
    ds_read_b64_tr_b16 v[126:127], v12 offset:29184
    ds_read_b64_tr_b16 v[128:129], v13 offset:32768
    ds_read_b64_tr_b16 v[130:131], v13 offset:33280
    ds_read_b64_tr_b16 v[132:133], v12 offset:32768
    ds_read_b64_tr_b16 v[134:135], v12 offset:33280
    s_waitcnt lgkmcnt(0)
    s_barrier
    s_waitcnt vmcnt(0)
    ds_write_b128 v11, v[200:203] offset:0
    ds_write_b128 v11, v[204:207] offset:1024
    ds_write_b128 v11, v[208:211] offset:2048
    ds_write_b128 v11, v[212:215] offset:3072
    ds_write_b128 v11, v[216:219] offset:4096
    ds_write_b128 v11, v[220:223] offset:5120
    ds_write_b128 v11, v[224:227] offset:6144
    ds_write_b128 v11, v[228:231] offset:7168
    ds_write_b128 v11, v[232:235] offset:8192
    v_cmp_eq_u32 s[48:49], 1, v3
    v_cmp_eq_u32 s[52:53], 2, v3
    v_cmp_eq_u32 s[60:61], 3, v3
    s_mul_i32 s58, s56, 576
    s_add_u32 s58, s58, 152064
    v_lshl_add_u32 v6, v3, 4, s58
    s_lshl_b32 s58, s56, 9
    s_lshl_b32 s54, s57, 6
    s_add_u32 s58, s58, s54
    s_add_u32 s58, s58, 153344
    v_lshl_add_u32 v7, v2, 2, s58
    v_lshlrev_b32 v9, 2, v0
    v_add_u32 v10, 153344, v9
    s_lshl_b32 s58, s40, 7
    s_add_u32 s58, s58, 154368
    v_lshl_add_u32 v11, v0, 1, s58
    v_lshl_add_u32 v12, v3, 4, s58
    s_mul_i32 s62, s3, 2304
    s_add_u32 s62, s62, 2387968
    s_lshl_b32 s58, s40, 6
    s_add_u32 s63, s62, s58
    s_add_u32 s63, s63, 2048
    s_lshl_b32 s58, s40, 8
    s_add_u32 s62, s62, s58
    s_waitcnt lgkmcnt(0)
    s_barrier
    ds_read_b64_tr_b16 v[136:137], v14 offset:0
    ds_read_b64_tr_b16 v[138:139], v14 offset:512
    ds_read_b64_tr_b16 v[140:141], v14 offset:36864
    ds_read_b64_tr_b16 v[142:143], v14 offset:37376
    ds_read_b64_tr_b16 v[144:145], v14 offset:2048
    ds_read_b64_tr_b16 v[146:147], v14 offset:2560
    ds_read_b64_tr_b16 v[148:149], v14 offset:38912
    ds_read_b64_tr_b16 v[150:151], v14 offset:39424
    s_waitcnt lgkmcnt(0)
    ds_read_b64_tr_b16 v[152:153], v14 offset:4096
    ds_read_b64_tr_b16 v[154:155], v14 offset:4608
    ds_read_b64_tr_b16 v[156:157], v14 offset:40960
    ds_read_b64_tr_b16 v[158:159], v14 offset:41472
    ds_read_b64_tr_b16 v[160:161], v14 offset:6144
    ds_read_b64_tr_b16 v[162:163], v14 offset:6656
    ds_read_b64_tr_b16 v[164:165], v14 offset:43008
    ds_read_b64_tr_b16 v[166:167], v14 offset:43520
    s_waitcnt lgkmcnt(0)
    ds_read_b64_tr_b16 v[168:169], v14 offset:8192
    ds_read_b64_tr_b16 v[170:171], v14 offset:8704
    ds_read_b64_tr_b16 v[172:173], v14 offset:45056
    ds_read_b64_tr_b16 v[174:175], v14 offset:45568
    s_waitcnt lgkmcnt(0)
    s_cmp_lg_u32 s40, 7
    s_cbranch_scc1 L_FWAIT
    v_readfirstlane_b32 s59, v251
    s_nop 0
    s_cmp_ge_u32 s59, 16
    s_cbranch_scc1 L_WC2_OK
    s_mov_b32 s76, s74
    s_mov_b32 s77, s75
    s_mov_b32 s78, 256
    s_mov_b32 s79, 0x00020000
    v_mov_b32 v250, 0
    s_mov_b32 s58, 0
L_WC2:
    buffer_load_dword v251, v250, s[76:79], 0 offen sc1
    s_add_u32 s58, s58, 1
    s_waitcnt vmcnt(0)
    v_readfirstlane_b32 s59, v251
    s_nop 0
    s_cmp_ge_u32 s59, 16
    s_cbranch_scc1 L_WC2_OK
    s_sleep 8
    s_cmp_lt_u32 s58, 400000
    s_cbranch_scc1 L_WC2
L_WC2_OK:
    s_mov_b32 s56, 2359296
    s_mov_b32 s55, 2367488
    s_mov_b32 s58, 0
    s_mov_b32 s45, -1
    v_lshlrev_b32 v8, 7, v0
    v_mov_b32 v28, 0
    v_mov_b32 v29, 0
    v_mov_b32 v30, 0
    v_mov_b32 v31, 0
    v_mov_b32 v32, -1
    v_mov_b32 v33, -1
    v_mov_b32 v34, -1
    v_mov_b32 v35, -1
L_KSLOW:
    buffer_load_dword v16, v8, s[36:39], s56 offen sc1
    buffer_load_dword v17, v8, s[36:39], s55 offen sc1
    s_add_u32 s58, s58, 1
    s_waitcnt vmcnt(0)
    v_min_u32 v20, v16, v17
    v_cmp_ne_u32 vcc, -1, v20
    s_cmp_lt_u32 s58, 400000
    s_cbranch_scc0 L_KFAST
    s_cmp_lg_u64 vcc, 0
    s_cbranch_scc1 L_KFAST
    s_sleep 6
    s_branch L_KSLOW
L_KFAST:
    s_mov_b32 s44, 0
    v_min_u32 v20, v16, v17
    v_cmp_eq_u32 s[50:51], -1, v16
    v_cmp_eq_u32 s[42:43], -1, v17
    v_min_u32_dpp v20, v20, v20 row_shr:1 row_mask:0xf bank_mask:0xf
    s_nop 1
    v_min_u32_dpp v20, v20, v20 row_shr:2 row_mask:0xf bank_mask:0xf
    s_nop 1
    v_min_u32_dpp v20, v20, v20 row_shr:4 row_mask:0xf bank_mask:0xf
    s_nop 1
    v_min_u32_dpp v20, v20, v20 row_shr:8 row_mask:0xf bank_mask:0xf
    s_nop 1
    v_min_u32_dpp v20, v20, v20 row_bcast:15 row_mask:0xa bank_mask:0xf
    s_nop 1
    v_min_u32_dpp v20, v20, v20 row_bcast:31 row_mask:0xc bank_mask:0xf
    s_nop 0
    v_readlane_b32 s57, v20, 63
    s_nop 0
    s_and_b32 s46, s57, 0x7ff
    s_lshr_b32 s46, s46, 4
    s_mul_i32 s47, s46, 1152
    s_add_u32 s47, s47, 2553856
    s_or_b64 exec, s[50:51], 1
    buffer_load_dword v32, v8, s[36:39], s56 offen sc1
    s_or_b64 exec, s[42:43], 1
    buffer_load_dword v33, v8, s[36:39], s55 offen sc1
    s_cmp_lg_u32 s45, s57
    s_cselect_b64 exec, -1, 1
    buffer_load_dwordx4 v[24:27], v4, s[36:39], s47 offen sc1
    s_cselect_b64 exec, 0xff, 1
    buffer_load_dwordx4 v[28:31], v5, s[36:39], s47 offen sc1
    s_mov_b64 exec, -1
    s_cselect_b32 s44, 0, s44
    s_add_u32 s44, s44, 1
    s_mov_b32 s45, s57
    s_or_b64 exec, s[50:51], 1
    buffer_load_dword v34, v8, s[36:39], s56 offen sc1
    s_or_b64 exec, s[42:43], 1
    buffer_load_dword v35, v8, s[36:39], s55 offen sc1
    s_cmp_lg_u32 s45, s57
    s_cselect_b64 exec, -1, 1
    buffer_load_dwordx4 v[24:27], v4, s[36:39], s47 offen sc1
    s_cselect_b64 exec, 0xff, 1
    buffer_load_dwordx4 v[28:31], v5, s[36:39], s47 offen sc1
    s_mov_b64 exec, -1
    s_cselect_b32 s44, 0, s44
    s_add_u32 s44, s44, 1
    s_mov_b32 s45, s57
L_KLOOP:
    s_waitcnt vmcnt(4)
    v_min_u32 v16, v16, v32
    v_min_u32 v17, v17, v33
    v_min_u32 v20, v16, v17
    v_cmp_eq_u32 s[50:51], -1, v16
    v_cmp_eq_u32 s[42:43], -1, v17
    v_min_u32_dpp v20, v20, v20 row_shr:1 row_mask:0xf bank_mask:0xf
    s_nop 1
    v_min_u32_dpp v20, v20, v20 row_shr:2 row_mask:0xf bank_mask:0xf
    s_nop 1
    v_min_u32_dpp v20, v20, v20 row_shr:4 row_mask:0xf bank_mask:0xf
    s_nop 1
    v_min_u32_dpp v20, v20, v20 row_shr:8 row_mask:0xf bank_mask:0xf
    s_nop 1
    v_min_u32_dpp v20, v20, v20 row_bcast:15 row_mask:0xa bank_mask:0xf
    s_nop 1
    v_min_u32_dpp v20, v20, v20 row_bcast:31 row_mask:0xc bank_mask:0xf
    s_nop 0
    v_readlane_b32 s57, v20, 63
    s_nop 0
    s_and_b32 s46, s57, 0x7ff
    s_lshr_b32 s46, s46, 4
    s_mul_i32 s47, s46, 1152
    s_add_u32 s47, s47, 2553856
    s_or_b64 vcc, s[50:51], s[42:43]
    s_cbranch_scc0 L_KALLK
    s_or_b64 exec, s[50:51], 1
    buffer_load_dword v32, v8, s[36:39], s56 offen sc1
    s_or_b64 exec, s[42:43], 1
    buffer_load_dword v33, v8, s[36:39], s55 offen sc1
    s_cmp_lg_u32 s45, s57
    s_cselect_b64 exec, -1, 1
    buffer_load_dwordx4 v[24:27], v4, s[36:39], s47 offen sc1
    s_cselect_b64 exec, 0xff, 1
    buffer_load_dwordx4 v[28:31], v5, s[36:39], s47 offen sc1
    s_mov_b64 exec, -1
    s_cselect_b32 s44, 0, s44
    s_add_u32 s44, s44, 1
    s_mov_b32 s45, s57
    s_waitcnt vmcnt(4)
    v_min_u32 v16, v16, v34
    v_min_u32 v17, v17, v35
    v_min_u32 v20, v16, v17
    v_cmp_eq_u32 s[50:51], -1, v16
    v_cmp_eq_u32 s[42:43], -1, v17
    v_min_u32_dpp v20, v20, v20 row_shr:1 row_mask:0xf bank_mask:0xf
    s_nop 1
    v_min_u32_dpp v20, v20, v20 row_shr:2 row_mask:0xf bank_mask:0xf
    s_nop 1
    v_min_u32_dpp v20, v20, v20 row_shr:4 row_mask:0xf bank_mask:0xf
    s_nop 1
    v_min_u32_dpp v20, v20, v20 row_shr:8 row_mask:0xf bank_mask:0xf
    s_nop 1
    v_min_u32_dpp v20, v20, v20 row_bcast:15 row_mask:0xa bank_mask:0xf
    s_nop 1
    v_min_u32_dpp v20, v20, v20 row_bcast:31 row_mask:0xc bank_mask:0xf
    s_nop 0
    v_readlane_b32 s57, v20, 63
    s_nop 0
    s_and_b32 s46, s57, 0x7ff
    s_lshr_b32 s46, s46, 4
    s_mul_i32 s47, s46, 1152
    s_add_u32 s47, s47, 2553856
    s_or_b64 vcc, s[50:51], s[42:43]
    s_cbranch_scc0 L_KALLK
    s_or_b64 exec, s[50:51], 1
    buffer_load_dword v34, v8, s[36:39], s56 offen sc1
    s_or_b64 exec, s[42:43], 1
    buffer_load_dword v35, v8, s[36:39], s55 offen sc1
    s_cmp_lg_u32 s45, s57
    s_cselect_b64 exec, -1, 1
    buffer_load_dwordx4 v[24:27], v4, s[36:39], s47 offen sc1
    s_cselect_b64 exec, 0xff, 1
    buffer_load_dwordx4 v[28:31], v5, s[36:39], s47 offen sc1
    s_mov_b64 exec, -1
    s_cselect_b32 s44, 0, s44
    s_add_u32 s44, s44, 1
    s_mov_b32 s45, s57
    s_add_u32 s58, s58, 1
    s_cmp_lt_u32 s58, 400000
    s_cbranch_scc1 L_KLOOP
L_KALLK:
    s_cmp_lg_u32 s45, s57
    s_cbranch_scc1 L_KROWLD
    s_cmp_ge_u32 s44, 2
    s_cbranch_scc1 L_KCHK2
    s_branch L_KCHK
L_KROWLD:
    buffer_load_dwordx4 v[24:27], v4, s[36:39], s47 offen sc1
    s_mov_b64 exec, 0xff
    buffer_load_dwordx4 v[28:31], v5, s[36:39], s47 offen sc1
    s_mov_b64 exec, -1
L_KCHK:
    s_waitcnt vmcnt(0)
L_KCHK2:
    s_add_u32 s58, s58, 1
    v_max3_u32 v20, v24, v25, v26
    v_max3_u32 v21, v27, v28, v29
    v_max3_u32 v20, v20, v30, v31
    v_max_u32 v20, v20, v21
    v_cmp_eq_u32 vcc, -1, v20
    s_cmp_lt_u32 s58, 800000
    s_cbranch_scc0 L_KGOT
    s_cmp_eq_u64 vcc, 0
    s_cbranch_scc0 L_KROWLD
L_KGOT:
    v_add_u32 v8, 152064, v4
    ds_write_b128 v8, v[24:27]
    s_mov_b64 exec, 0xff
    ds_write_b128 v8, v[28:31] offset:1024
    s_mov_b64 exec, -1
    s_waitcnt lgkmcnt(0)
L_FWAIT:
    s_barrier
    ds_read_b128 v[176:179], v6 offset:0
    ds_read_b128 v[180:183], v6 offset:64
    ds_read_b128 v[184:187], v6 offset:128
    ds_read_b128 v[188:191], v6 offset:192
    ds_read_b128 v[192:195], v6 offset:256
    ds_read_b128 v[196:199], v6 offset:320
    ds_read_b128 v[200:203], v6 offset:384
    ds_read_b128 v[204:207], v6 offset:448
    ds_read_b128 v[208:211], v6 offset:512
    s_waitcnt lgkmcnt(8)
    v_mfma_f32_16x16x32_bf16 v[52:55], v[176:179], v[64:67], 0
    v_mfma_f32_16x16x32_bf16 v[56:59], v[176:179], v[68:71], 0
    s_waitcnt lgkmcnt(7)
    v_mfma_f32_16x16x32_bf16 v[52:55], v[180:183], v[72:75], v[52:55]
    v_mfma_f32_16x16x32_bf16 v[56:59], v[180:183], v[76:79], v[56:59]
    s_waitcnt lgkmcnt(6)
    v_mfma_f32_16x16x32_bf16 v[52:55], v[184:187], v[80:83], v[52:55]
    v_mfma_f32_16x16x32_bf16 v[56:59], v[184:187], v[84:87], v[56:59]
    s_waitcnt lgkmcnt(5)
    v_mfma_f32_16x16x32_bf16 v[52:55], v[188:191], v[88:91], v[52:55]
    v_mfma_f32_16x16x32_bf16 v[56:59], v[188:191], v[92:95], v[56:59]
    s_waitcnt lgkmcnt(4)
    v_mfma_f32_16x16x32_bf16 v[52:55], v[192:195], v[96:99], v[52:55]
    v_mfma_f32_16x16x32_bf16 v[56:59], v[192:195], v[100:103], v[56:59]
    s_waitcnt lgkmcnt(3)
    v_mfma_f32_16x16x32_bf16 v[52:55], v[196:199], v[104:107], v[52:55]
    v_mfma_f32_16x16x32_bf16 v[56:59], v[196:199], v[108:111], v[56:59]
    s_waitcnt lgkmcnt(2)
    v_mfma_f32_16x16x32_bf16 v[52:55], v[200:203], v[112:115], v[52:55]
    v_mfma_f32_16x16x32_bf16 v[56:59], v[200:203], v[116:119], v[56:59]
    s_waitcnt lgkmcnt(1)
    v_mfma_f32_16x16x32_bf16 v[52:55], v[204:207], v[120:123], v[52:55]
    v_mfma_f32_16x16x32_bf16 v[56:59], v[204:207], v[124:127], v[56:59]
    s_waitcnt lgkmcnt(0)
    v_mfma_f32_16x16x32_bf16 v[52:55], v[208:211], v[128:131], v[52:55]
    v_mfma_f32_16x16x32_bf16 v[56:59], v[208:211], v[132:135], v[56:59]
    s_mov_b64 exec, 0xffff
    s_nop 6
    ds_write2st64_b32 v7, v52, v56 offset0:0 offset1:1
    s_mov_b64 exec, -1
    s_waitcnt lgkmcnt(0)
    s_barrier
    ds_read2st64_b32 v[16:17], v10 offset0:0 offset1:1
    ds_read2st64_b32 v[18:19], v10 offset0:2 offset1:3
    s_waitcnt vmcnt(0) lgkmcnt(0)
    v_pk_add_f32 v[16:17], v[16:17], v[18:19]
    v_cvt_pk_bf16_f32 v18, v16, v17
    v_lshlrev_b32 v16, 16, v18
    v_and_b32 v17, 0xffff0000, v18
    v_mul_f32 v19, 0xbfb8aa3b, v16
    v_exp_f32 v19, v19
    s_nop 0
    v_add_f32 v19, 1.0, v19
    v_rcp_f32 v19, v19
    s_nop 0
    v_mul_f32 v19, v19, v16
    v_cvt_pk_bf16_f32 v19, v19, v19
    v_and_b32 v19, 0xffff0000, v19
    v_mul_f32 v19, v19, v17
    v_cvt_pk_bf16_f32 v19, v19, v19
    ds_write_b16 v11, v19
    s_waitcnt lgkmcnt(0)
    ds_read_b128 v[20:23], v12
    ds_read_b128 v[24:27], v12 offset:64
    s_waitcnt lgkmcnt(1)
    v_mfma_f32_16x16x32_bf16 v[28:31], v[20:23], v[136:139], 0
    v_mfma_f32_16x16x32_bf16 v[32:35], v[20:23], v[144:147], 0
    v_mfma_f32_16x16x32_bf16 v[36:39], v[20:23], v[152:155], 0
    v_mfma_f32_16x16x32_bf16 v[40:43], v[20:23], v[160:163], 0
    v_mfma_f32_16x16x32_bf16 v[44:47], v[20:23], v[168:171], 0
    s_waitcnt lgkmcnt(0)
    v_mfma_f32_16x16x32_bf16 v[28:31], v[24:27], v[140:143], v[28:31]
    v_mfma_f32_16x16x32_bf16 v[32:35], v[24:27], v[148:151], v[32:35]
    v_mfma_f32_16x16x32_bf16 v[36:39], v[24:27], v[156:159], v[36:39]
    v_mfma_f32_16x16x32_bf16 v[40:43], v[24:27], v[164:167], v[40:43]
    v_mfma_f32_16x16x32_bf16 v[44:47], v[24:27], v[172:175], v[44:47]
    v_mov_b32 v17, 0x7fc00000
    s_nop 3
    v_cndmask_b32 v16, v28, v32, s[48:49]
    v_cndmask_b32 v16, v16, v36, s[52:53]
    v_cndmask_b32 v16, v16, v40, s[60:61]
    v_cmp_eq_u32 vcc, -1, v16
    s_nop 1
    v_cndmask_b32 v16, v16, v17, vcc
    buffer_store_dword v16, v9, s[36:39], s62 offen sc1
    s_cmp_ge_u32 s40, 4
    s_cbranch_scc1 L_FDONE
    v_cmp_eq_u32 vcc, -1, v44
    s_nop 1
    v_cndmask_b32 v18, v44, v17, vcc
    s_mov_b64 exec, 0xffff
    buffer_store_dword v18, v9, s[36:39], s63 offen sc1
    s_mov_b64 exec, -1
L_FDONE:
    s_branch L_EXIT
L_FIN:
    v_and_b32 v2, 15, v0
    v_lshrrev_b32 v3, 4, v0
    v_lshlrev_b32 v4, 4, v0
    v_add_u32 v5, 1024, v4
    v_lshlrev_b32 v9, 2, v0
    s_mov_b32 s36, s14
    s_mov_b32 s37, s15
    s_mov_b32 s38, 9437184
    s_mov_b32 s39, 0x00020000
    s_sub_u32 s42, s2, 72
    s_mul_i32 s41, s40, 20736
    s_lshl_b32 s43, s42, 8
    s_add_u32 s41, s41, s43
    s_add_u32 s41, s41, 2387968
    s_lshl_b32 s45, s40, 8
    v_add_u32 v10, s45, v9
    s_mov_b32 s32, s72
    s_mov_b32 s33, s73
    s_mov_b32 s34, 2359296
    s_mov_b32 s35, 0x00020000
    s_lshl_b32 s44, s42, 4
    s_cmp_lt_u32 s42, 8
    s_cselect_b32 s43, 7, 4
    s_cselect_b32 s44, s44, 512
    v_lshlrev_b32 v12, s43, v3
    v_add3_u32 v12, v12, v2, s44
    v_lshlrev_b32 v12, 1, v12
    v_mov_b32 v63, 0
    s_cmp_lg_u32 s40, 7
    s_cbranch_scc1 L_NWAIT
    s_mov_b32 s56, 2359296
    s_mov_b32 s55, 2367488
    s_mov_b32 s58, 0
    s_mov_b32 s45, -1
    v_lshlrev_b32 v8, 7, v0
    v_mov_b32 v28, 0
    v_mov_b32 v29, 0
    v_mov_b32 v30, 0
    v_mov_b32 v31, 0
    v_mov_b32 v32, -1
    v_mov_b32 v33, -1
    v_mov_b32 v34, -1
    v_mov_b32 v35, -1
L_NSLOW:
    buffer_load_dword v16, v8, s[36:39], s56 offen sc1
    buffer_load_dword v17, v8, s[36:39], s55 offen sc1
    s_add_u32 s58, s58, 1
    s_waitcnt vmcnt(0)
    v_min_u32 v20, v16, v17
    v_cmp_ne_u32 vcc, -1, v20
    s_cmp_lt_u32 s58, 400000
    s_cbranch_scc0 L_NFAST
    s_cmp_lg_u64 vcc, 0
    s_cbranch_scc1 L_NFAST
    s_sleep 6
    s_branch L_NSLOW
L_NFAST:
    s_mov_b32 s44, 0
    v_min_u32 v20, v16, v17
    v_cmp_eq_u32 s[50:51], -1, v16
    v_cmp_eq_u32 s[42:43], -1, v17
    v_min_u32_dpp v20, v20, v20 row_shr:1 row_mask:0xf bank_mask:0xf
    s_nop 1
    v_min_u32_dpp v20, v20, v20 row_shr:2 row_mask:0xf bank_mask:0xf
    s_nop 1
    v_min_u32_dpp v20, v20, v20 row_shr:4 row_mask:0xf bank_mask:0xf
    s_nop 1
    v_min_u32_dpp v20, v20, v20 row_shr:8 row_mask:0xf bank_mask:0xf
    s_nop 1
    v_min_u32_dpp v20, v20, v20 row_bcast:15 row_mask:0xa bank_mask:0xf
    s_nop 1
    v_min_u32_dpp v20, v20, v20 row_bcast:31 row_mask:0xc bank_mask:0xf
    s_nop 0
    v_readlane_b32 s57, v20, 63
    s_nop 0
    s_and_b32 s46, s57, 0x7ff
    s_lshr_b32 s46, s46, 4
    s_mul_i32 s47, s46, 1152
    s_add_u32 s47, s47, 2553856
    s_or_b64 exec, s[50:51], 1
    buffer_load_dword v32, v8, s[36:39], s56 offen sc1
    s_or_b64 exec, s[42:43], 1
    buffer_load_dword v33, v8, s[36:39], s55 offen sc1
    s_cmp_lg_u32 s45, s57
    s_cselect_b64 exec, -1, 1
    buffer_load_dwordx4 v[24:27], v4, s[36:39], s47 offen sc1
    s_cselect_b64 exec, 0xff, 1
    buffer_load_dwordx4 v[28:31], v5, s[36:39], s47 offen sc1
    s_mov_b64 exec, -1
    s_cselect_b32 s44, 0, s44
    s_add_u32 s44, s44, 1
    s_mov_b32 s45, s57
    s_or_b64 exec, s[50:51], 1
    buffer_load_dword v34, v8, s[36:39], s56 offen sc1
    s_or_b64 exec, s[42:43], 1
    buffer_load_dword v35, v8, s[36:39], s55 offen sc1
    s_cmp_lg_u32 s45, s57
    s_cselect_b64 exec, -1, 1
    buffer_load_dwordx4 v[24:27], v4, s[36:39], s47 offen sc1
    s_cselect_b64 exec, 0xff, 1
    buffer_load_dwordx4 v[28:31], v5, s[36:39], s47 offen sc1
    s_mov_b64 exec, -1
    s_cselect_b32 s44, 0, s44
    s_add_u32 s44, s44, 1
    s_mov_b32 s45, s57
L_NLOOP:
    s_waitcnt vmcnt(4)
    v_min_u32 v16, v16, v32
    v_min_u32 v17, v17, v33
    v_min_u32 v20, v16, v17
    v_cmp_eq_u32 s[50:51], -1, v16
    v_cmp_eq_u32 s[42:43], -1, v17
    v_min_u32_dpp v20, v20, v20 row_shr:1 row_mask:0xf bank_mask:0xf
    s_nop 1
    v_min_u32_dpp v20, v20, v20 row_shr:2 row_mask:0xf bank_mask:0xf
    s_nop 1
    v_min_u32_dpp v20, v20, v20 row_shr:4 row_mask:0xf bank_mask:0xf
    s_nop 1
    v_min_u32_dpp v20, v20, v20 row_shr:8 row_mask:0xf bank_mask:0xf
    s_nop 1
    v_min_u32_dpp v20, v20, v20 row_bcast:15 row_mask:0xa bank_mask:0xf
    s_nop 1
    v_min_u32_dpp v20, v20, v20 row_bcast:31 row_mask:0xc bank_mask:0xf
    s_nop 0
    v_readlane_b32 s57, v20, 63
    s_nop 0
    s_and_b32 s46, s57, 0x7ff
    s_lshr_b32 s46, s46, 4
    s_mul_i32 s47, s46, 1152
    s_add_u32 s47, s47, 2553856
    s_or_b64 vcc, s[50:51], s[42:43]
    s_cbranch_scc0 L_NALLK
    s_or_b64 exec, s[50:51], 1
    buffer_load_dword v32, v8, s[36:39], s56 offen sc1
    s_or_b64 exec, s[42:43], 1
    buffer_load_dword v33, v8, s[36:39], s55 offen sc1
    s_cmp_lg_u32 s45, s57
    s_cselect_b64 exec, -1, 1
    buffer_load_dwordx4 v[24:27], v4, s[36:39], s47 offen sc1
    s_cselect_b64 exec, 0xff, 1
    buffer_load_dwordx4 v[28:31], v5, s[36:39], s47 offen sc1
    s_mov_b64 exec, -1
    s_cselect_b32 s44, 0, s44
    s_add_u32 s44, s44, 1
    s_mov_b32 s45, s57
    s_waitcnt vmcnt(4)
    v_min_u32 v16, v16, v34
    v_min_u32 v17, v17, v35
    v_min_u32 v20, v16, v17
    v_cmp_eq_u32 s[50:51], -1, v16
    v_cmp_eq_u32 s[42:43], -1, v17
    v_min_u32_dpp v20, v20, v20 row_shr:1 row_mask:0xf bank_mask:0xf
    s_nop 1
    v_min_u32_dpp v20, v20, v20 row_shr:2 row_mask:0xf bank_mask:0xf
    s_nop 1
    v_min_u32_dpp v20, v20, v20 row_shr:4 row_mask:0xf bank_mask:0xf
    s_nop 1
    v_min_u32_dpp v20, v20, v20 row_shr:8 row_mask:0xf bank_mask:0xf
    s_nop 1
    v_min_u32_dpp v20, v20, v20 row_bcast:15 row_mask:0xa bank_mask:0xf
    s_nop 1
    v_min_u32_dpp v20, v20, v20 row_bcast:31 row_mask:0xc bank_mask:0xf
    s_nop 0
    v_readlane_b32 s57, v20, 63
    s_nop 0
    s_and_b32 s46, s57, 0x7ff
    s_lshr_b32 s46, s46, 4
    s_mul_i32 s47, s46, 1152
    s_add_u32 s47, s47, 2553856
    s_or_b64 vcc, s[50:51], s[42:43]
    s_cbranch_scc0 L_NALLK
    s_or_b64 exec, s[50:51], 1
    buffer_load_dword v34, v8, s[36:39], s56 offen sc1
    s_or_b64 exec, s[42:43], 1
    buffer_load_dword v35, v8, s[36:39], s55 offen sc1
    s_cmp_lg_u32 s45, s57
    s_cselect_b64 exec, -1, 1
    buffer_load_dwordx4 v[24:27], v4, s[36:39], s47 offen sc1
    s_cselect_b64 exec, 0xff, 1
    buffer_load_dwordx4 v[28:31], v5, s[36:39], s47 offen sc1
    s_mov_b64 exec, -1
    s_cselect_b32 s44, 0, s44
    s_add_u32 s44, s44, 1
    s_mov_b32 s45, s57
    s_add_u32 s58, s58, 1
    s_cmp_lt_u32 s58, 400000
    s_cbranch_scc1 L_NLOOP
L_NALLK:
    s_cmp_lg_u32 s45, s57
    s_cbranch_scc1 L_NROWLD
    s_cmp_ge_u32 s44, 2
    s_cbranch_scc1 L_NCHK2
    s_branch L_NCHK
L_NROWLD:
    buffer_load_dwordx4 v[24:27], v4, s[36:39], s47 offen sc1
    s_mov_b64 exec, 0xff
    buffer_load_dwordx4 v[28:31], v5, s[36:39], s47 offen sc1
    s_mov_b64 exec, -1
L_NCHK:
    s_waitcnt vmcnt(0)
L_NCHK2:
    s_add_u32 s58, s58, 1
    v_max3_u32 v20, v24, v25, v26
    v_max3_u32 v21, v27, v28, v29
    v_max3_u32 v20, v20, v30, v31
    v_max_u32 v20, v20, v21
    v_cmp_eq_u32 vcc, -1, v20
    s_cmp_lt_u32 s58, 800000
    s_cbranch_scc0 L_NGOT
    s_cmp_eq_u64 vcc, 0
    s_cbranch_scc0 L_NROWLD
L_NGOT:
L_NWAIT:
    s_barrier
    s_cmp_lg_u32 s40, 7
    s_cbranch_scc1 L_PP
    s_lshl_b32 s48, s46, 7
    s_add_u32 s48, s48, 2359360
    v_mov_b32 v8, 0
    s_mov_b32 s58, 0
L_FPOLL:
    buffer_load_dword v11, v8, s[36:39], s48 offen sc1
    s_add_u32 s58, s58, 1
    s_waitcnt vmcnt(0)
    v_readfirstlane_b32 s44, v11
    s_nop 0
    s_cmp_lg_u32 s44, -1
    s_cbranch_scc1 L_FGOT2
    s_cmp_lt_u32 s58, 400000
    s_cbranch_scc1 L_FPOLL
L_FGOT2:
    s_mul_i32 s45, s46, 1280
    s_add_u32 s45, s45, 2752512
    v_mov_b32 v60, 0
    v_mov_b32 v61, 0
    buffer_load_short_d16_hi v60, v12, s[36:39], s47 offen sc1
    buffer_load_short_d16_hi v61, v12, s[36:39], s45 offen sc1
    buffer_load_dwordx2 v[62:63], v8, s[36:39], s45 offen offset:1152 sc1
L_PP:
    s_mov_b32 s58, 0
L_PPOLL:
    s_mov_b32 s43, s41
    buffer_load_dword v32, v9, s[36:39], s43 offen sc1
    s_add_u32 s43, s43, 2304
    buffer_load_dword v33, v9, s[36:39], s43 offen sc1
    s_add_u32 s43, s43, 2304
    buffer_load_dword v34, v9, s[36:39], s43 offen sc1
    s_add_u32 s43, s43, 2304
    buffer_load_dword v35, v9, s[36:39], s43 offen sc1
    s_add_u32 s43, s43, 2304
    buffer_load_dword v36, v9, s[36:39], s43 offen sc1
    s_add_u32 s43, s43, 2304
    buffer_load_dword v37, v9, s[36:39], s43 offen sc1
    s_add_u32 s43, s43, 2304
    buffer_load_dword v38, v9, s[36:39], s43 offen sc1
    s_add_u32 s43, s43, 2304
    buffer_load_dword v39, v9, s[36:39], s43 offen sc1
    s_add_u32 s43, s43, 2304
    buffer_load_dword v40, v9, s[36:39], s43 offen sc1
    s_add_u32 s58, s58, 1
    s_waitcnt vmcnt(0)
    v_max3_u32 v16, v32, v33, v34
    v_max3_u32 v17, v35, v36, v37
    v_max3_u32 v18, v38, v39, v40
    v_max3_u32 v16, v16, v17, v18
    v_cmp_eq_u32 vcc, -1, v16
    v_pk_add_f32 v[18:19], v[32:33], v[34:35]
    v_pk_add_f32 v[20:21], v[36:37], v[38:39]
    s_cmp_eq_u64 vcc, 0
    s_cbranch_scc1 L_PGOT
    s_cmp_lt_u32 s58, 400000
    s_cbranch_scc1 L_PPOLL
L_PGOT:
    v_pk_add_f32 v[18:19], v[18:19], v[20:21]
    v_add_f32 v18, v18, v40
    v_add_f32 v18, v18, v19
    ds_write_b32 v10, v18
    s_waitcnt lgkmcnt(0)
    s_barrier
    s_cmp_lg_u32 s40, 7
    s_cbranch_scc1 L_EXIT
    ds_read2st64_b32 v[16:17], v9 offset0:0 offset1:1
    ds_read2st64_b32 v[18:19], v9 offset0:2 offset1:3
    ds_read2st64_b32 v[20:21], v9 offset0:4 offset1:5
    ds_read2st64_b32 v[22:23], v9 offset0:6 offset1:7
    v_cvt_pk_bf16_f32 v62, v62, v62
    v_and_b32 v62, 0xffff0000, v62
    v_mul_f32 v30, 0xbfb8aa3b, v62
    v_exp_f32 v30, v30
    v_mul_u32_u24 v63, 1152, v63
    v_add_f32 v30, 1.0, v30
    v_rcp_f32 v30, v30
    v_add_u32 v63, v63, v12
    v_cvt_pk_bf16_f32 v30, v30, v30
    v_and_b32 v30, 0xffff0000, v30
    s_waitcnt lgkmcnt(0)
    v_pk_add_f32 v[16:17], v[16:17], v[18:19]
    v_pk_add_f32 v[20:21], v[20:21], v[22:23]
    v_pk_add_f32 v[16:17], v[16:17], v[20:21]
    v_add_f32 v16, v16, v17
    v_cvt_pk_bf16_f32 v16, v16, v16
    v_and_b32 v16, 0xffff0000, v16
    v_mul_f32 v16, v16, v30
    v_cvt_pk_bf16_f32 v16, v16, v16
    v_and_b32 v16, 0xffff0000, v16
    v_add_f32 v16, v16, v60
    v_cvt_pk_bf16_f32 v16, v16, v16
    v_and_b32 v16, 0xffff0000, v16
    v_add_f32 v16, v16, v61
    v_cvt_pk_bf16_f32 v16, v16, v16
    buffer_store_short v16, v63, s[32:35], 0 offen
L_EXIT:
L_END:
    s_endpgm
CODE_END:
.section .rodata,"a"
.p2align 6
.amdhsa_kernel sequential_preLN__spectral_fnet__moe_arch_mod__prompt_kernel
  .amdhsa_next_free_vgpr 256
  .amdhsa_next_free_sgpr 88
  .amdhsa_accum_offset 256
  .amdhsa_group_segment_fixed_size 0
  .amdhsa_kernarg_size 104
  .amdhsa_user_sgpr_count 2
  .amdhsa_user_sgpr_kernarg_segment_ptr 1
  .amdhsa_system_sgpr_workgroup_id_x 1
.end_amdhsa_kernel
```
